```python
import torch

def _softmax(x, axis=-1):
    return torch.softmax(x, dim=axis)
def _gelu(x):
    return torch.nn.functional.gelu(x, approximate="tanh")
def _silu(x):
    return torch.nn.functional.silu(x)
def _sigmoid(x):
    return torch.sigmoid(x)
def _layernorm(x, axis=-1, eps=1e-5):
    m = x.mean(dim=axis, keepdim=True)
    v = x.var(dim=axis, keepdim=True, unbiased=False)
    return (x - m) / torch.sqrt(v + eps)
def _scatter_add(tgt, idx, src, axis=0):
    return tgt.clone().index_add_(axis, idx, src)
def _segment_sum(src, seg, n):
    out = torch.zeros((n,) + src.shape[1:], dtype=src.dtype)
    return out.index_add_(0, seg, src)
def _pad(x, pw):
    flat = tuple(v for pair in reversed(pw) for v in pair)
    return torch.nn.functional.pad(x, flat)

kernel_name = 'concat_heads__gqa_block_cached__mha_block_cached__near_ridge'

def setup_inputs():

    _w = (lambda a: (lambda t: t.to(torch.bfloat16) if t.is_floating_point() else t)(torch.as_tensor(a)))
    def _A_setup():
        B, Sq, D = 32, 32, 448
        Hq, Hkv, Sk, Dh = 16, 8, 32, 256
        assert Hq % Hkv == 0, (Hq, Hkv)
        return {
            "x": _w((lambda *s: torch.randn(*s, dtype=torch.bfloat16) * 0.8)(B, Sq, D)),
            "k_cache": _w((lambda *s: torch.randn(*s, dtype=torch.bfloat16) * 0.8)(B, Hkv, Sk, Dh)),
            "v_cache": _w((lambda *s: torch.randn(*s, dtype=torch.bfloat16) * 0.05)(B, Hkv, Sk, Dh)),
            "wq": _w((lambda *s: torch.randn(*s, dtype=torch.bfloat16) * 0.8)(D, Hq * Dh) * (D ** -0.5)),
            "wo": _w((lambda *s: torch.randn(*s, dtype=torch.bfloat16) * 0.05)(Hq * Dh, D) * ((Hq * Dh) ** -0.5)),
        }
    _A_in = _A_setup()

    def _B_setup():
        B, Sq, D = 32, 32, 448
        H, Sk, Dh = 16, 32, 256
        return {
            "x": _w((lambda *s: torch.randn(*s, dtype=torch.bfloat16) * 0.8)(B, Sq, D)),
            "k_cache": _w((lambda *s: torch.randn(*s, dtype=torch.bfloat16) * 0.8)(B, H, Sk, Dh)),
            "v_cache": _w((lambda *s: torch.randn(*s, dtype=torch.bfloat16) * 0.05)(B, H, Sk, Dh)),
            "wq": _w((lambda *s: torch.randn(*s, dtype=torch.bfloat16) * 0.8)(D, H * Dh) * (D ** -0.5)),
            "wo": _w((lambda *s: torch.randn(*s, dtype=torch.bfloat16) * 0.05)(H * Dh, D) * ((H * Dh) ** -0.5)),
        }
    _B_in = _B_setup()

    return {
        "A_x": _A_in["x"],
        "A_k_cache": _A_in["k_cache"],
        "A_v_cache": _A_in["v_cache"],
        "A_wq": _A_in["wq"],
        "A_wo": _A_in["wo"],
        "B_x": _B_in["x"],
        "B_k_cache": _B_in["k_cache"],
        "B_v_cache": _B_in["v_cache"],
        "B_wq": _B_in["wq"],
        "B_wo": _B_in["wo"],
    }

def reference(A_x, A_k_cache, A_v_cache, A_wq, A_wo, B_x, B_k_cache, B_v_cache, B_wq, B_wo):
    def _A_ref(x, k_cache, v_cache, wq, wo):
        B, Sq, D = x.shape
        Hq, Dh = 16, 256
        Hkv = k_cache.shape[1]
        rep = Hq // Hkv
        q = (lambda x, *d: x.permute(*d))((x @ wq).reshape(B, Sq, Hq, Dh), 0, 2, 1, 3)
        k = (lambda x, n, axis: torch.repeat_interleave(x, n, dim=axis))(k_cache, rep, axis=1)
        v = (lambda x, n, axis: torch.repeat_interleave(x, n, dim=axis))(v_cache, rep, axis=1)
        scores = torch.einsum("bhqd,bhkd->bhqk", q, k) * (Dh ** -0.5)
        p = _softmax(scores, axis=-1)
        o = torch.einsum("bhqk,bhkd->bhqd", p, v)
        return (lambda x, *d: x.permute(*d))(o, 0, 2, 1, 3).reshape(B, Sq, Hq * Dh) @ wo

    def _B_ref(x, k_cache, v_cache, wq, wo):
        B, Sq, D = x.shape
        H, Dh = 16, 256
        q = (lambda x, *d: x.permute(*d))((x @ wq).reshape(B, Sq, H, Dh), 0, 2, 1, 3)
        scores = torch.einsum("bhqd,bhkd->bhqk", q, k_cache) * (Dh ** -0.5)
        p = _softmax(scores, axis=-1)
        o = torch.einsum("bhqk,bhkd->bhqd", p, v_cache)
        return (lambda x, *d: x.permute(*d))(o, 0, 2, 1, 3).reshape(B, Sq, H * Dh) @ wo

    a = _A_ref(A_x, A_k_cache, A_v_cache, A_wq, A_wo)
    b = _B_ref(B_x, B_k_cache, B_v_cache, B_wq, B_wo)
    return torch.concatenate([a, b], axis=-1)
```

```asm
; @launch grid=(256,1,1) block=(512,1,1) lds=163840
.amdgcn_target "amdgcn-amd-amdhsa--gfx950"
.text
.globl concat_heads__gqa_block_cached__mha_block_cached__near_ridge_kernel
.p2align 12
.p2align 8
.type concat_heads__gqa_block_cached__mha_block_cached__near_ridge_kernel,@function
concat_heads__gqa_block_cached__mha_block_cached__near_ridge_kernel:
    s_cmp_ge_u32 s2, 256
    s_cbranch_scc1 L_end
    s_load_dwordx16 s[4:19], s[0:1], 0
    s_load_dwordx8 s[20:27], s[0:1], 64
    s_load_dwordx2 s[28:29], s[0:1], 96
    v_lshrrev_b32 v1, 6, v0
    v_and_b32 v2, 63, v0
    v_readfirstlane_b32 s30, v1
    s_and_b32 s31, s2, 1
    s_bfe_u32 s32, s2, 0x20001
    s_lshr_b32 s33, s2, 5
    s_bfe_u32 s34, s2, 0x20003
    s_and_b32 s35, s34, 1
    s_and_b32 s3, s34, 2
    s_lshl1_add_u32 s35, s3, s35
    s_and_b32 s3, s32, 1
    s_lshl1_add_u32 s35, s3, s35
    s_and_b32 s3, s32, 2
    s_lshl2_add_u32 s35, s3, s35
    s_lshl_b32 s36, 0x20000, s31
    s_sub_u32 s37, 1, s31
    s_cmp_lt_u32 s30, 4
    s_cbranch_scc1 L_mfma
    s_sub_u32 s69, s30, 4
    v_lshrrev_b32 v3, 5, v2
    v_and_b32 v4, 31, v2
    s_and_b32 s3, s69, 1
    s_lshl_b32 s3, s3, 3
    s_lshl_b32 s38, s69, 3
    v_lshl_or_b32 v5, v3, 1, s3
    v_xor_b32 v5, v5, v4
    v_add_u32 v6, s38, v3
    v_mul_u32_u24 v6, 8192, v6
    v_lshl_add_u32 v8, v5, 4, v6
    v_xor_b32 v5, 4, v5
    v_lshl_add_u32 v9, v5, 4, v6
    v_add_u32 v9, 15360, v9
    v_add_u32 v10, 30720, v8
    v_add_u32 v11, 30720, v9
    v_lshrrev_b32 v3, 3, v2
    v_and_b32 v4, 7, v2
    v_lshrrev_b32 v7, 4, v2
    v_xor_b32 v4, v4, v7
    s_lshl_b32 s38, s69, 5
    v_add_u32 v3, s38, v3
    v_mul_u32_u24 v6, 896, v3
    v_lshl_add_u32 v16, v4, 4, v6
    v_xor_b32 v4, 4, v4
    v_lshl_add_u32 v17, v4, 4, v6
    v_add_u32 v17, 6144, v17
    v_add_u32 v18, 12288, v16
    v_add_u32 v19, 12288, v17
    s_lshl_b32 s86, s69, 12
    s_add_u32 s87, s86, 65536
    s_mov_b32 s100, 0
    s_add_u32 s89, s34, s33
    s_add_u32 s100, s89, 0
    s_and_b32 s100, s100, 1
    s_add_u32 s100, s100, 0
    s_and_b32 s101, s33, 3
    s_mov_b32 s88, s100
    s_lshl_b32 s90, s35, 9
    s_mul_i32 s91, s33, 114688
    s_bfe_u32 s3, s33, 65538
    s_lshl_b32 s3, s3, 18
    s_add_u32 s90, s90, s3
    s_mov_b32 s42, 3670016
    s_mov_b32 s43, 0x20000
    s_mov_b32 s46, 917504
    s_mov_b32 s47, 0x20000
    s_lshl_b32 s98, s88, 19
    s_add_u32 s98, s98, s90
    s_lshl_b32 s99, s88, 7
    s_add_u32 s99, s99, s91
    s_mov_b32 m0, s86
    s_cmp_eq_u32 s31, 0
    s_waitcnt lgkmcnt(0)
    s_cselect_b32 s40, s10, s20
    s_cselect_b32 s41, s11, s21
    buffer_load_dwordx4 v8, s[40:43], s98 offen offset:0 lds
    buffer_load_dwordx4 v9, s[40:43], s98 offen offset:1024 lds
    buffer_load_dwordx4 v10, s[40:43], s98 offen offset:2048 lds
    buffer_load_dwordx4 v11, s[40:43], s98 offen offset:3072 lds
    s_cselect_b32 s44, s4, s14
    s_cselect_b32 s45, s5, s15
    s_mov_b32 m0, s87
    s_cselect_b32 s48, s6, s16
    buffer_load_dwordx4 v16, s[44:47], s99 offen offset:0 lds
    buffer_load_dwordx4 v17, s[44:47], s99 offen offset:1024 lds
    buffer_load_dwordx4 v18, s[44:47], s99 offen offset:2048 lds
    buffer_load_dwordx4 v19, s[44:47], s99 offen offset:3072 lds
    s_cselect_b32 s49, s7, s17
    s_cselect_b32 s52, s8, s18
    s_cselect_b32 s53, s9, s19
    s_cselect_b32 s56, s12, s22
    s_cselect_b32 s57, s13, s23
    s_mov_b32 s4, s98
    s_add_u32 s88, s88, 1
    s_cmp_eq_u32 s88, 7
    s_cselect_b32 s88, 0, s88
    s_bfe_u32 s16, s33, 65538
    s_lshl_b32 s3, s16, 19
    s_sub_u32 s17, 262144, s3
    s_mul_i32 s3, s16, 57344
    s_sub_u32 s18, 28672, s3
    v_lshrrev_b32 v3, 5, v2
    v_and_b32 v4, 31, v2
    s_and_b32 s3, s69, 1
    s_lshl_b32 s3, s3, 3
    s_lshl_b32 s38, s69, 3
    v_lshl_or_b32 v5, v3, 1, s3
    v_xor_b32 v5, v5, v4
    v_add_u32 v6, s38, v3
    v_mul_u32_u24 v6, 896, v6
    v_lshl_add_u32 v32, v5, 4, v6
    v_xor_b32 v5, 4, v5
    v_lshl_add_u32 v33, v5, 4, v6
    v_add_u32 v33, 768, v33
    v_add_u32 v34, 1536, v32
    v_add_u32 v35, 1536, v33
    v_lshrrev_b32 v3, 3, v2
    v_and_b32 v4, 7, v2
    v_lshrrev_b32 v7, 4, v2
    v_xor_b32 v4, v4, v7
    v_mul_u32_u24 v6, 512, v3
    v_lshl_add_u32 v20, v4, 4, v6
    v_xor_b32 v4, 4, v4
    v_lshl_add_u32 v21, v4, 4, v6
    v_add_u32 v21, 3072, v21
    v_add_u32 v22, 6144, v20
    v_add_u32 v23, 6144, v21
    s_lshl_b32 s3, 0x400000, s31
    s_and_b32 s49, s49, 0xffff
    s_mov_b32 s50, s3
    s_mov_b32 s51, 0x20000
    s_and_b32 s53, s53, 0xffff
    s_mov_b32 s54, s3
    s_mov_b32 s55, 0x20000
    s_and_b32 s57, s57, 0xffff
    s_mov_b32 s58, 3670016
    s_mov_b32 s59, 0x20000
    s_add_u32 s60, s28, 0
    s_addc_u32 s61, s29, 0
    s_and_b32 s61, s61, 0xffff
    s_mov_b32 s62, 20971520
    s_mov_b32 s63, 0x20000
    s_mov_b32 s64, s24
    s_and_b32 s65, s25, 0xffff
    s_mov_b32 s66, 1835008
    s_mov_b32 s67, 0x20000
    s_lshl_b32 s3, s31, 3
    s_add_u32 s3, s3, s33
    s_lshl_b32 s3, s3, 7
    s_add_u32 s38, s60, s3
    s_addc_u32 s39, s61, 0
    s_load_dword s68, s[38:39], 0
    s_cmp_lg_u32 s69, 0
    s_cbranch_scc1 L_nopf
    s_getpc_b64 s[38:39]
L_pc:
    s_sub_u32 s38, s38, L_pc-concat_heads__gqa_block_cached__mha_block_cached__near_ridge_kernel
    s_subb_u32 s39, s39, 0
    s_lshr_b32 s3, s2, 3
    s_mul_i32 s3, s3, 1152
    v_min_u32 v5, 8, v2
    v_lshl_add_u32 v5, v5, 7, s3
    v_min_u32 v5, L_last-concat_heads__gqa_block_cached__mha_block_cached__near_ridge_kernel, v5
    global_load_dword v15, v5, s[38:39]
L_nopf:
    v_lshrrev_b32 v3, 5, v2
    v_and_b32 v4, 31, v2
    v_bfe_u32 v7, v2, 4, 1
    v_xor_b32 v7, s69, v7
    v_mul_lo_u32 v7, v7, s36
    v_add_u32 v6, 0, v3
    v_xor_b32 v5, v6, v4
    v_lshlrev_b32 v5, 4, v5
    v_lshl_add_u32 v5, v6, 9, v5
    v_add_u32 v24, v5, v7
    v_add_u32 v6, 2, v3
    v_xor_b32 v5, v6, v4
    v_lshlrev_b32 v5, 4, v5
    v_lshl_add_u32 v5, v6, 9, v5
    v_add_u32 v25, v5, v7
    v_subrev_u32 v25, 1024, v25
    v_add_u32 v6, 4, v3
    v_xor_b32 v5, v6, v4
    v_lshlrev_b32 v5, 4, v5
    v_lshl_add_u32 v5, v6, 9, v5
    v_add_u32 v26, v5, v7
    v_subrev_u32 v26, 2048, v26
    v_add_u32 v6, 6, v3
    v_xor_b32 v5, v6, v4
    v_lshlrev_b32 v5, 4, v5
    v_lshl_add_u32 v5, v6, 9, v5
    v_add_u32 v27, v5, v7
    v_subrev_u32 v27, 3072, v27
    v_add_u32 v6, 8, v3
    v_xor_b32 v5, v6, v4
    v_lshlrev_b32 v5, 4, v5
    v_lshl_add_u32 v5, v6, 9, v5
    v_add_u32 v28, v5, v7
    v_add_u32 v6, 10, v3
    v_xor_b32 v5, v6, v4
    v_lshlrev_b32 v5, 4, v5
    v_lshl_add_u32 v5, v6, 9, v5
    v_add_u32 v29, v5, v7
    v_subrev_u32 v29, 1024, v29
    v_add_u32 v6, 12, v3
    v_xor_b32 v5, v6, v4
    v_lshlrev_b32 v5, 4, v5
    v_lshl_add_u32 v5, v6, 9, v5
    v_add_u32 v30, v5, v7
    v_subrev_u32 v30, 2048, v30
    v_add_u32 v6, 14, v3
    v_xor_b32 v5, v6, v4
    v_lshlrev_b32 v5, 4, v5
    v_lshl_add_u32 v5, v6, 9, v5
    v_add_u32 v31, v5, v7
    v_subrev_u32 v31, 3072, v31
    s_lshr_b32 s3, s35, s37
    s_lshl_b32 s3, s3, 14
    s_lshl_b32 s6, s33, 2
    s_mul_i32 s6, s6, s36
    s_add_u32 s6, s6, s3
    s_add_u32 s7, s6, 8192
    s_mul_i32 s11, s69, s36
    s_add_u32 s9, s6, s11
    s_lshl_b32 s3, s31, 14
    s_xor_b32 s10, s9, s3
    s_lshl_b32 s8, s69, 14
    s_add_u32 s8, s8, 98304
    s_lshl_b32 s94, s31, 3
    s_add_u32 s94, s94, s33
    s_lshl_b32 s94, s94, 1
    s_and_b32 s3, s34, 1
    s_add_u32 s94, s94, s3
    s_lshl_b32 s95, s32, 1
    s_lshr_b32 s3, s34, 1
    s_add_u32 s95, s95, s3
    v_min_u32 v1, 1, v2
    v_lshlrev_b32 v1, 31, v1
    v_lshlrev_b32 v2, 4, v2
    s_lshl_b32 s3, s69, 12
    s_add_u32 s3, s3, 131072
    v_add_u32 v0, s3, v2
    s_mov_b32 s26, 0x3db8aa3b
    s_mov_b32 s27, s26
    s_lshl_b32 s20, s2, 13
    s_lshl_b32 s3, s69, 11
    s_add_u32 s20, s20, s3
    s_add_u32 s20, s20, 1048576
    s_xor_b32 s22, s20, 65536
    s_lshl_b32 s21, s2, 9
    s_lshl_b32 s3, s69, 7
    s_add_u32 s21, s21, s3
    s_add_u32 s21, s21, 0x80000
    s_xor_b32 s23, s21, 4096
    s_lshl_b32 s3, s94, 3
    s_add_u32 s3, s3, s95
    s_lshl_b32 s97, s3, 10
    s_add_u32 s97, s97, 262144
    s_mul_i32 s96, s3, 57344
    s_add_u32 s96, s96, 4194304
    s_lshl_b32 s3, s69, 10
    s_add_u32 s96, s96, s3
    s_lshr_b32 s3, s95, 1
    s_lshl_b32 s92, s33, 2
    s_add_u32 s3, s3, s92
    s_mul_i32 s92, s3, 57344
    s_mul_i32 s3, s31, 896
    s_add_u32 s92, s92, s3
    s_and_b32 s3, s34, 1
    s_mul_i32 s3, s3, 448
    s_add_u32 s92, s92, s3
    s_and_b32 s3, s95, 1
    s_mul_i32 s3, s3, 224
    s_add_u32 s92, s92, s3
    s_lshl_b32 s3, s69, 5
    s_add_u32 s92, s92, s3
    s_add_u32 s93, s92, 28672
    v_bfe_u32 v12, v2, 4, 4
    v_mul_u32_u24 v12, 1792, v12
    v_lshrrev_b32 v14, 8, v2
    v_lshl_add_u32 v12, v14, 3, v12
    s_lshl_b32 s3, s69, 10
    s_add_u32 s3, s3, 147456
    v_add_u32 v13, s3, v2
    s_add_u32 s4, s4, s17
    s_add_u32 m0, s86, 16384
    s_nop 0
    buffer_load_dwordx4 v8, s[40:43], s4 offen offset:0 lds
    buffer_load_dwordx4 v9, s[40:43], s4 offen offset:1024 lds
    buffer_load_dwordx4 v10, s[40:43], s4 offen offset:2048 lds
    buffer_load_dwordx4 v11, s[40:43], s4 offen offset:3072 lds
    s_waitcnt vmcnt(4)
    s_barrier
    s_add_u32 s88, s89, 1
    s_and_b32 s88, s88, 1
    s_add_u32 s88, s88, 0
    s_lshl_b32 s4, s88, 19
    s_add_u32 s4, s4, s90
    s_add_u32 m0, s86, 32768
    s_nop 0
    buffer_load_dwordx4 v8, s[40:43], s4 offen offset:0 lds
    buffer_load_dwordx4 v9, s[40:43], s4 offen offset:1024 lds
    buffer_load_dwordx4 v10, s[40:43], s4 offen offset:2048 lds
    buffer_load_dwordx4 v11, s[40:43], s4 offen offset:3072 lds
    s_add_u32 s100, s89, 1
    s_and_b32 s100, s100, 1
    s_add_u32 s100, s100, 0
    s_lshl_b32 s5, s100, 7
    s_add_u32 s5, s5, s91
    s_add_u32 m0, s87, 16384
    s_nop 0
    buffer_load_dwordx4 v16, s[44:47], s5 offen offset:0 lds
    buffer_load_dwordx4 v17, s[44:47], s5 offen offset:1024 lds
    buffer_load_dwordx4 v18, s[44:47], s5 offen offset:2048 lds
    buffer_load_dwordx4 v19, s[44:47], s5 offen offset:3072 lds
    s_waitcnt vmcnt(8)
    s_barrier
    s_add_u32 s4, s4, s17
    s_add_u32 m0, s86, 49152
    s_nop 0
    buffer_load_dwordx4 v8, s[40:43], s4 offen offset:0 lds
    buffer_load_dwordx4 v9, s[40:43], s4 offen offset:1024 lds
    buffer_load_dwordx4 v10, s[40:43], s4 offen offset:2048 lds
    buffer_load_dwordx4 v11, s[40:43], s4 offen offset:3072 lds
    s_add_u32 s3, s89, 0
    s_mul_i32 s88, s3, 21846
    s_lshr_b32 s88, s88, 16
    s_mul_i32 s88, s88, 3
    s_sub_u32 s88, s3, s88
    s_add_u32 s88, s88, 2
    s_lshl_b32 s4, s88, 19
    s_add_u32 s4, s4, s90
    s_add_u32 m0, s86, 0
    s_nop 0
    buffer_load_dwordx4 v8, s[40:43], s4 offen offset:0 lds
    buffer_load_dwordx4 v9, s[40:43], s4 offen offset:1024 lds
    buffer_load_dwordx4 v10, s[40:43], s4 offen offset:2048 lds
    buffer_load_dwordx4 v11, s[40:43], s4 offen offset:3072 lds
    s_add_u32 m0, s8, 0
    s_nop 0
    buffer_load_dwordx4 v24, s[48:51], s6 offen offset:0 lds
    buffer_load_dwordx4 v25, s[48:51], s6 offen offset:1024 lds
    buffer_load_dwordx4 v26, s[48:51], s6 offen offset:2048 lds
    buffer_load_dwordx4 v27, s[48:51], s6 offen offset:3072 lds
    s_waitcnt vmcnt(12)
    s_barrier
    s_add_u32 s4, s4, s17
    s_add_u32 m0, s86, 16384
    s_nop 0
    buffer_load_dwordx4 v8, s[40:43], s4 offen offset:0 lds
    buffer_load_dwordx4 v9, s[40:43], s4 offen offset:1024 lds
    buffer_load_dwordx4 v10, s[40:43], s4 offen offset:2048 lds
    buffer_load_dwordx4 v11, s[40:43], s4 offen offset:3072 lds
    s_add_u32 s3, s89, 0
    s_mul_i32 s100, s3, 21846
    s_lshr_b32 s100, s100, 16
    s_mul_i32 s100, s100, 3
    s_sub_u32 s100, s3, s100
    s_add_u32 s100, s100, 2
    s_lshl_b32 s5, s100, 7
    s_add_u32 s5, s5, s91
    s_add_u32 m0, s87, 0
    s_nop 0
    buffer_load_dwordx4 v16, s[44:47], s5 offen offset:0 lds
    buffer_load_dwordx4 v17, s[44:47], s5 offen offset:1024 lds
    buffer_load_dwordx4 v18, s[44:47], s5 offen offset:2048 lds
    buffer_load_dwordx4 v19, s[44:47], s5 offen offset:3072 lds
    s_waitcnt vmcnt(16)
    s_barrier
    s_add_u32 s3, s89, 1
    s_mul_i32 s88, s3, 21846
    s_lshr_b32 s88, s88, 16
    s_mul_i32 s88, s88, 3
    s_sub_u32 s88, s3, s88
    s_add_u32 s88, s88, 2
    s_lshl_b32 s4, s88, 19
    s_add_u32 s4, s4, s90
    s_add_u32 m0, s86, 32768
    s_nop 0
    buffer_load_dwordx4 v8, s[40:43], s4 offen offset:0 lds
    buffer_load_dwordx4 v9, s[40:43], s4 offen offset:1024 lds
    buffer_load_dwordx4 v10, s[40:43], s4 offen offset:2048 lds
    buffer_load_dwordx4 v11, s[40:43], s4 offen offset:3072 lds
    s_add_u32 m0, s8, 4096
    s_nop 0
    buffer_load_dwordx4 v28, s[48:51], s6 offen offset:0 lds
    buffer_load_dwordx4 v29, s[48:51], s6 offen offset:1024 lds
    buffer_load_dwordx4 v30, s[48:51], s6 offen offset:2048 lds
    buffer_load_dwordx4 v31, s[48:51], s6 offen offset:3072 lds
    s_waitcnt vmcnt(8)
    s_barrier
    s_add_u32 s4, s4, s17
    s_add_u32 m0, s86, 49152
    s_nop 0
    buffer_load_dwordx4 v8, s[40:43], s4 offen offset:0 lds
    buffer_load_dwordx4 v9, s[40:43], s4 offen offset:1024 lds
    buffer_load_dwordx4 v10, s[40:43], s4 offen offset:2048 lds
    buffer_load_dwordx4 v11, s[40:43], s4 offen offset:3072 lds
    s_add_u32 s3, s89, 1
    s_mul_i32 s100, s3, 21846
    s_lshr_b32 s100, s100, 16
    s_mul_i32 s100, s100, 3
    s_sub_u32 s100, s3, s100
    s_add_u32 s100, s100, 2
    s_lshl_b32 s5, s100, 7
    s_add_u32 s5, s5, s91
    s_add_u32 m0, s87, 16384
    s_nop 0
    buffer_load_dwordx4 v16, s[44:47], s5 offen offset:0 lds
    buffer_load_dwordx4 v17, s[44:47], s5 offen offset:1024 lds
    buffer_load_dwordx4 v18, s[44:47], s5 offen offset:2048 lds
    buffer_load_dwordx4 v19, s[44:47], s5 offen offset:3072 lds
    s_barrier
    s_add_u32 s3, s89, 2
    s_mul_i32 s88, s3, 21846
    s_lshr_b32 s88, s88, 16
    s_mul_i32 s88, s88, 3
    s_sub_u32 s88, s3, s88
    s_add_u32 s88, s88, 2
    s_lshl_b32 s4, s88, 19
    s_add_u32 s4, s4, s90
    s_add_u32 m0, s86, 0
    s_nop 0
    buffer_load_dwordx4 v8, s[40:43], s4 offen offset:0 lds
    buffer_load_dwordx4 v9, s[40:43], s4 offen offset:1024 lds
    buffer_load_dwordx4 v10, s[40:43], s4 offen offset:2048 lds
    buffer_load_dwordx4 v11, s[40:43], s4 offen offset:3072 lds
    s_waitcnt vmcnt(4)
    s_barrier
    s_add_u32 s4, s4, s17
    s_add_u32 m0, s86, 16384
    s_nop 0
    buffer_load_dwordx4 v8, s[40:43], s4 offen offset:0 lds
    buffer_load_dwordx4 v9, s[40:43], s4 offen offset:1024 lds
    buffer_load_dwordx4 v10, s[40:43], s4 offen offset:2048 lds
    buffer_load_dwordx4 v11, s[40:43], s4 offen offset:3072 lds
    s_add_u32 s3, s89, 2
    s_mul_i32 s100, s3, 21846
    s_lshr_b32 s100, s100, 16
    s_mul_i32 s100, s100, 3
    s_sub_u32 s100, s3, s100
    s_add_u32 s100, s100, 2
    s_lshl_b32 s5, s100, 7
    s_add_u32 s5, s5, s91
    s_add_u32 m0, s87, 0
    s_nop 0
    buffer_load_dwordx4 v16, s[44:47], s5 offen offset:0 lds
    buffer_load_dwordx4 v17, s[44:47], s5 offen offset:1024 lds
    buffer_load_dwordx4 v18, s[44:47], s5 offen offset:2048 lds
    buffer_load_dwordx4 v19, s[44:47], s5 offen offset:3072 lds
    s_waitcnt lgkmcnt(0)
    s_add_u32 s68, s68, 0x9E3779B9
    s_barrier
    s_add_u32 s88, s89, 0
    s_and_b32 s88, s88, 1
    s_add_u32 s88, s88, 5
    s_lshl_b32 s4, s88, 19
    s_add_u32 s4, s4, s90
    s_add_u32 m0, s86, 32768
    s_nop 0
    buffer_load_dwordx4 v8, s[40:43], s4 offen offset:0 lds
    buffer_load_dwordx4 v9, s[40:43], s4 offen offset:1024 lds
    buffer_load_dwordx4 v10, s[40:43], s4 offen offset:2048 lds
    buffer_load_dwordx4 v11, s[40:43], s4 offen offset:3072 lds
    s_add_u32 m0, s8, 8192
    s_nop 0
    buffer_load_dwordx4 v24, s[48:51], s7 offen offset:0 lds
    buffer_load_dwordx4 v25, s[48:51], s7 offen offset:1024 lds
    buffer_load_dwordx4 v26, s[48:51], s7 offen offset:2048 lds
    buffer_load_dwordx4 v27, s[48:51], s7 offen offset:3072 lds
    s_waitcnt vmcnt(8)
    s_barrier
    s_add_u32 s4, s4, s17
    s_add_u32 m0, s86, 49152
    s_nop 0
    buffer_load_dwordx4 v8, s[40:43], s4 offen offset:0 lds
    buffer_load_dwordx4 v9, s[40:43], s4 offen offset:1024 lds
    buffer_load_dwordx4 v10, s[40:43], s4 offen offset:2048 lds
    buffer_load_dwordx4 v11, s[40:43], s4 offen offset:3072 lds
    s_add_u32 s100, s89, 0
    s_and_b32 s100, s100, 1
    s_add_u32 s100, s100, 5
    s_lshl_b32 s5, s100, 7
    s_add_u32 s5, s5, s91
    s_add_u32 m0, s87, 16384
    s_nop 0
    buffer_load_dwordx4 v16, s[44:47], s5 offen offset:0 lds
    buffer_load_dwordx4 v17, s[44:47], s5 offen offset:1024 lds
    buffer_load_dwordx4 v18, s[44:47], s5 offen offset:2048 lds
    buffer_load_dwordx4 v19, s[44:47], s5 offen offset:3072 lds
    s_barrier
    s_add_u32 s88, s89, 1
    s_and_b32 s88, s88, 1
    s_add_u32 s88, s88, 5
    s_lshl_b32 s4, s88, 19
    s_add_u32 s4, s4, s90
    s_add_u32 m0, s86, 0
    s_nop 0
    buffer_load_dwordx4 v8, s[40:43], s4 offen offset:0 lds
    buffer_load_dwordx4 v9, s[40:43], s4 offen offset:1024 lds
    buffer_load_dwordx4 v10, s[40:43], s4 offen offset:2048 lds
    buffer_load_dwordx4 v11, s[40:43], s4 offen offset:3072 lds
    s_add_u32 m0, s8, 12288
    s_nop 0
    buffer_load_dwordx4 v28, s[48:51], s7 offen offset:0 lds
    buffer_load_dwordx4 v29, s[48:51], s7 offen offset:1024 lds
    buffer_load_dwordx4 v30, s[48:51], s7 offen offset:2048 lds
    buffer_load_dwordx4 v31, s[48:51], s7 offen offset:3072 lds
    s_waitcnt vmcnt(8)
    s_barrier
    s_add_u32 s4, s4, s17
    s_add_u32 m0, s86, 16384
    s_nop 0
    buffer_load_dwordx4 v8, s[40:43], s4 offen offset:0 lds
    buffer_load_dwordx4 v9, s[40:43], s4 offen offset:1024 lds
    buffer_load_dwordx4 v10, s[40:43], s4 offen offset:2048 lds
    buffer_load_dwordx4 v11, s[40:43], s4 offen offset:3072 lds
    s_add_u32 s100, s89, 1
    s_and_b32 s100, s100, 1
    s_add_u32 s100, s100, 5
    s_lshl_b32 s5, s100, 7
    s_add_u32 s5, s5, s91
    s_add_u32 m0, s87, 0
    s_nop 0
    buffer_load_dwordx4 v16, s[44:47], s5 offen offset:0 lds
    buffer_load_dwordx4 v17, s[44:47], s5 offen offset:1024 lds
    buffer_load_dwordx4 v18, s[44:47], s5 offen offset:2048 lds
    buffer_load_dwordx4 v19, s[44:47], s5 offen offset:3072 lds
    s_barrier
    s_xor_b32 s3, s35, 0
    s_mul_i32 s90, s3, 229376
    s_and_b32 s3, s34, 1
    s_mul_i32 s3, s3, 384
    s_add_u32 s90, s90, s3
    s_mul_i32 s3, s16, 28672
    s_add_u32 s90, s90, s3
    s_add_u32 s3, s101, 0
    s_and_b32 s3, s3, 3
    s_mul_i32 s4, s3, 57344
    s_add_u32 s4, s4, s90
    s_add_u32 m0, s86, 32768
    s_nop 0
    buffer_load_dwordx4 v32, s[56:59], s4 offen offset:0 lds
    buffer_load_dwordx4 v33, s[56:59], s4 offen offset:1024 lds
    buffer_load_dwordx4 v34, s[56:59], s4 offen offset:2048 lds
    buffer_load_dwordx4 v35, s[56:59], s4 offen offset:3072 lds
    s_waitcnt vmcnt(4)
    s_barrier
    s_add_u32 s4, s4, s18
    s_add_u32 m0, s86, 49152
    s_nop 0
    buffer_load_dwordx4 v32, s[56:59], s4 offen offset:0 lds
    buffer_load_dwordx4 v33, s[56:59], s4 offen offset:1024 lds
    buffer_load_dwordx4 v34, s[56:59], s4 offen offset:2048 lds
    buffer_load_dwordx4 v35, s[56:59], s4 offen offset:3072 lds
    s_add_u32 s3, s101, 0
    s_and_b32 s3, s3, 3
    s_lshl_b32 s3, s3, 7
    s_add_u32 s5, s3, s9
    s_add_u32 m0, s87, 16384
    s_nop 0
    buffer_load_dwordx4 v20, s[52:55], s5 offen offset:0 lds
    buffer_load_dwordx4 v21, s[52:55], s5 offen offset:1024 lds
    buffer_load_dwordx4 v22, s[52:55], s5 offen offset:2048 lds
    buffer_load_dwordx4 v23, s[52:55], s5 offen offset:3072 lds
    s_barrier
    s_add_u32 s3, s101, 1
    s_and_b32 s3, s3, 3
    s_mul_i32 s4, s3, 57344
    s_add_u32 s4, s4, s90
    s_add_u32 m0, s86, 0
    s_nop 0
    buffer_load_dwordx4 v32, s[56:59], s4 offen offset:0 lds
    buffer_load_dwordx4 v33, s[56:59], s4 offen offset:1024 lds
    buffer_load_dwordx4 v34, s[56:59], s4 offen offset:2048 lds
    buffer_load_dwordx4 v35, s[56:59], s4 offen offset:3072 lds
    s_barrier
    s_add_u32 s4, s4, s18
    s_add_u32 m0, s86, 16384
    s_nop 0
    buffer_load_dwordx4 v32, s[56:59], s4 offen offset:0 lds
L_pg0:
    s_cbranch_execz L_pg4
    buffer_load_dwordx4 v33, s[56:59], s4 offen offset:1024 lds
    buffer_load_dwordx4 v34, s[56:59], s4 offen offset:2048 lds
    buffer_load_dwordx4 v35, s[56:59], s4 offen offset:3072 lds
    s_add_u32 s3, s101, 1
    s_and_b32 s3, s3, 3
    s_lshl_b32 s3, s3, 7
    s_add_u32 s5, s3, s9
    s_add_u32 m0, s87, 0
    s_nop 0
    buffer_load_dwordx4 v20, s[52:55], s5 offen offset:0 lds
    buffer_load_dwordx4 v21, s[52:55], s5 offen offset:1024 lds
    buffer_load_dwordx4 v22, s[52:55], s5 offen offset:2048 lds
    buffer_load_dwordx4 v23, s[52:55], s5 offen offset:3072 lds
    s_waitcnt vmcnt(12)
    s_barrier
    s_add_u32 s3, s101, 2
    s_and_b32 s3, s3, 3
    s_lshl_b32 s3, s3, 7
    s_add_u32 s5, s3, s9
    s_add_u32 m0, s87, 49152
    s_nop 0
    buffer_load_dwordx4 v20, s[52:55], s5 offen offset:0 lds
    buffer_load_dwordx4 v21, s[52:55], s5 offen offset:1024 lds
    buffer_load_dwordx4 v22, s[52:55], s5 offen offset:2048 lds
    buffer_load_dwordx4 v23, s[52:55], s5 offen offset:3072 lds
    s_barrier
    ds_read_b128 v[128:131], v0 offset:0
    ds_read_b128 v[144:147], v0 offset:16384
    ds_read_b128 v[132:135], v0 offset:1024
    ds_read_b128 v[148:151], v0 offset:17408
    ds_read_b128 v[136:139], v0 offset:2048
    ds_read_b128 v[152:155], v0 offset:18432
    ds_read_b128 v[140:143], v0 offset:3072
    ds_read_b128 v[156:159], v0 offset:19456
    s_barrier
    s_add_u32 s3, s101, 2
    s_and_b32 s3, s3, 3
    s_mul_i32 s4, s3, 57344
    s_add_u32 s4, s4, s90
    s_add_u32 m0, s86, 32768
    s_nop 0
    buffer_load_dwordx4 v32, s[56:59], s4 offen offset:0 lds
    buffer_load_dwordx4 v33, s[56:59], s4 offen offset:1024 lds
    buffer_load_dwordx4 v34, s[56:59], s4 offen offset:2048 lds
    buffer_load_dwordx4 v35, s[56:59], s4 offen offset:3072 lds
    s_add_u32 s3, s101, 3
    s_and_b32 s3, s3, 3
    s_lshl_b32 s3, s3, 7
    s_add_u32 s5, s3, s9
    s_add_u32 m0, s87, 32768
    s_nop 0
    buffer_load_dwordx4 v20, s[52:55], s5 offen offset:0 lds
    buffer_load_dwordx4 v21, s[52:55], s5 offen offset:1024 lds
    buffer_load_dwordx4 v22, s[52:55], s5 offen offset:2048 lds
    buffer_load_dwordx4 v23, s[52:55], s5 offen offset:3072 lds
    s_waitcnt lgkmcnt(6)
    v_pk_add_f32 v[128:129], v[128:129], v[144:145]
    v_pk_add_f32 v[130:131], v[130:131], v[146:147]
    s_waitcnt lgkmcnt(4)
    v_pk_add_f32 v[132:133], v[132:133], v[148:149]
    v_pk_add_f32 v[134:135], v[134:135], v[150:151]
    s_waitcnt lgkmcnt(2)
    v_pk_add_f32 v[136:137], v[136:137], v[152:153]
    v_pk_add_f32 v[138:139], v[138:139], v[154:155]
    s_waitcnt lgkmcnt(0)
    v_pk_add_f32 v[140:141], v[140:141], v[156:157]
    v_pk_add_f32 v[142:143], v[142:143], v[158:159]
    v_max3_f32 v160, v128, v129, v130
    v_max3_f32 v162, v132, v133, v134
    v_max3_f32 v160, v160, v131, v136
    v_max3_f32 v162, v162, v135, v140
    v_max3_f32 v160, v160, v137, v138
    v_max3_f32 v162, v162, v141, v142
    v_max_f32 v160, v160, v139
    v_max_f32 v162, v162, v143
    v_mov_b32 v161, v160
    v_mov_b32 v163, v162
    s_nop 0
    v_permlane32_swap_b32 v160, v161
    v_permlane32_swap_b32 v162, v163
    v_max_f32 v160, v160, v161
    v_max_f32 v162, v162, v163
    v_mov_b32 v161, v160
    v_mov_b32 v163, v162
    s_nop 0
    v_permlane16_swap_b32 v160, v161
    v_permlane16_swap_b32 v162, v163
    v_max_f32 v160, v160, v161
    v_max_f32 v162, v162, v163
    v_mul_f32 v160, s26, v160
    v_mul_f32 v162, s26, v162
    v_pk_fma_f32 v[128:129], v[128:129], s[26:27], v[160:161] op_sel_hi:[1,0,0] neg_lo:[0,0,1] neg_hi:[0,0,1]
    v_pk_fma_f32 v[132:133], v[132:133], s[26:27], v[162:163] op_sel_hi:[1,0,0] neg_lo:[0,0,1] neg_hi:[0,0,1]
    v_pk_fma_f32 v[130:131], v[130:131], s[26:27], v[160:161] op_sel_hi:[1,0,0] neg_lo:[0,0,1] neg_hi:[0,0,1]
    v_pk_fma_f32 v[134:135], v[134:135], s[26:27], v[162:163] op_sel_hi:[1,0,0] neg_lo:[0,0,1] neg_hi:[0,0,1]
    v_pk_fma_f32 v[136:137], v[136:137], s[26:27], v[160:161] op_sel_hi:[1,0,0] neg_lo:[0,0,1] neg_hi:[0,0,1]
    v_pk_fma_f32 v[140:141], v[140:141], s[26:27], v[162:163] op_sel_hi:[1,0,0] neg_lo:[0,0,1] neg_hi:[0,0,1]
    v_pk_fma_f32 v[138:139], v[138:139], s[26:27], v[160:161] op_sel_hi:[1,0,0] neg_lo:[0,0,1] neg_hi:[0,0,1]
    v_pk_fma_f32 v[142:143], v[142:143], s[26:27], v[162:163] op_sel_hi:[1,0,0] neg_lo:[0,0,1] neg_hi:[0,0,1]
    v_exp_f32 v128, v128
    v_exp_f32 v132, v132
    v_exp_f32 v129, v129
    v_exp_f32 v133, v133
    v_exp_f32 v130, v130
    v_exp_f32 v134, v134
    v_exp_f32 v131, v131
    v_exp_f32 v135, v135
    v_exp_f32 v136, v136
    v_exp_f32 v140, v140
    s_waitcnt vmcnt(12)
    s_barrier
    s_add_u32 s4, s4, s18
    s_add_u32 m0, s86, 49152
    s_nop 0
    buffer_load_dwordx4 v32, s[56:59], s4 offen offset:0 lds
    buffer_load_dwordx4 v33, s[56:59], s4 offen offset:1024 lds
    buffer_load_dwordx4 v34, s[56:59], s4 offen offset:2048 lds
    buffer_load_dwordx4 v35, s[56:59], s4 offen offset:3072 lds
    v_exp_f32 v137, v137
    v_exp_f32 v141, v141
    v_exp_f32 v138, v138
    v_exp_f32 v142, v142
    v_exp_f32 v139, v139
    v_exp_f32 v143, v143
    v_pk_add_f32 v[164:165], v[128:129], v[130:131]
    v_pk_add_f32 v[166:167], v[132:133], v[134:135]
    v_pk_add_f32 v[164:165], v[164:165], v[136:137]
    v_pk_add_f32 v[166:167], v[166:167], v[140:141]
    v_pk_add_f32 v[164:165], v[164:165], v[138:139]
    v_pk_add_f32 v[166:167], v[166:167], v[142:143]
    v_add_f32 v164, v164, v165
    v_add_f32 v166, v166, v167
    v_mov_b32 v161, v164
    v_mov_b32 v163, v166
    s_nop 0
    v_permlane32_swap_b32 v164, v161
    v_permlane32_swap_b32 v166, v163
    v_add_f32 v164, v164, v161
    v_add_f32 v166, v166, v163
    v_mov_b32 v161, v164
    v_mov_b32 v163, v166
    s_nop 0
    v_permlane16_swap_b32 v164, v161
    v_permlane16_swap_b32 v166, v163
    v_add_f32 v164, v164, v161
    v_add_f32 v166, v166, v163
    v_rcp_f32 v164, v164
    v_rcp_f32 v166, v166
    v_pk_mul_f32 v[128:129], v[128:129], v[164:165] op_sel_hi:[1,0]
    v_pk_mul_f32 v[132:133], v[132:133], v[166:167] op_sel_hi:[1,0]
    v_pk_mul_f32 v[130:131], v[130:131], v[164:165] op_sel_hi:[1,0]
    v_pk_mul_f32 v[134:135], v[134:135], v[166:167] op_sel_hi:[1,0]
    v_pk_mul_f32 v[136:137], v[136:137], v[164:165] op_sel_hi:[1,0]
    v_pk_mul_f32 v[140:141], v[140:141], v[166:167] op_sel_hi:[1,0]
    v_pk_mul_f32 v[138:139], v[138:139], v[164:165] op_sel_hi:[1,0]
    v_pk_mul_f32 v[142:143], v[142:143], v[166:167] op_sel_hi:[1,0]
    v_cvt_pk_bf16_f32 v168, v128, v129
    v_cvt_pk_bf16_f32 v172, v132, v133
    v_cvt_pk_bf16_f32 v169, v130, v131
    v_cvt_pk_bf16_f32 v173, v134, v135
    v_cvt_pk_bf16_f32 v170, v136, v137
    v_cvt_pk_bf16_f32 v174, v140, v141
    v_cvt_pk_bf16_f32 v171, v138, v139
    v_cvt_pk_bf16_f32 v175, v142, v143
    ds_write_b128 v0, v[168:171] offset:0
    buffer_store_dwordx4 v[168:171], v2, s[60:63], s20 offen offset:0 sc1
    ds_write_b128 v0, v[172:175] offset:1024
    buffer_store_dwordx4 v[172:175], v2, s[60:63], s20 offen offset:1024 sc1
    s_cmp_eq_u32 s31, 0
    s_cbranch_scc1 L_gqa
    s_barrier
    s_add_u32 s3, s101, 3
    s_and_b32 s3, s3, 3
    s_mul_i32 s4, s3, 57344
    s_add_u32 s4, s4, s90
    s_add_u32 m0, s86, 0
    s_nop 0
    buffer_load_dwordx4 v32, s[56:59], s4 offen offset:0 lds
    buffer_load_dwordx4 v33, s[56:59], s4 offen offset:1024 lds
    buffer_load_dwordx4 v34, s[56:59], s4 offen offset:2048 lds
    buffer_load_dwordx4 v35, s[56:59], s4 offen offset:3072 lds
    s_add_u32 s3, s101, 0
    s_and_b32 s3, s3, 3
    s_lshl_b32 s3, s3, 7
    s_add_u32 s5, s3, s10
    s_add_u32 m0, s87, 16384
    s_nop 0
    buffer_load_dwordx4 v20, s[52:55], s5 offen offset:0 lds
    buffer_load_dwordx4 v21, s[52:55], s5 offen offset:1024 lds
    buffer_load_dwordx4 v22, s[52:55], s5 offen offset:2048 lds
    buffer_load_dwordx4 v23, s[52:55], s5 offen offset:3072 lds
    s_waitcnt vmcnt(18)
    s_barrier
    s_add_u32 s4, s4, s18
    s_add_u32 m0, s86, 16384
    s_nop 0
    buffer_load_dwordx4 v32, s[56:59], s4 offen offset:0 lds
    buffer_load_dwordx4 v33, s[56:59], s4 offen offset:1024 lds
    buffer_load_dwordx4 v34, s[56:59], s4 offen offset:2048 lds
    buffer_load_dwordx4 v35, s[56:59], s4 offen offset:3072 lds
    s_waitcnt vmcnt(12)
    v_mov_b32 v6, s68
    buffer_atomic_swap v6, v1, s[60:63], s21 offen sc1
    s_barrier
    s_xor_b32 s3, s35, 1
    s_mul_i32 s90, s3, 229376
    s_and_b32 s3, s34, 1
    s_mul_i32 s3, s3, 384
    s_add_u32 s90, s90, s3
    s_mul_i32 s3, s16, 28672
    s_add_u32 s90, s90, s3
    s_add_u32 s3, s101, 0
    s_and_b32 s3, s3, 3
    s_mul_i32 s4, s3, 57344
    s_add_u32 s4, s4, s90
    s_add_u32 m0, s86, 32768
    s_nop 0
    buffer_load_dwordx4 v32, s[56:59], s4 offen offset:0 lds
    buffer_load_dwordx4 v33, s[56:59], s4 offen offset:1024 lds
    buffer_load_dwordx4 v34, s[56:59], s4 offen offset:2048 lds
    buffer_load_dwordx4 v35, s[56:59], s4 offen offset:3072 lds
    s_add_u32 s3, s101, 1
    s_and_b32 s3, s3, 3
    s_lshl_b32 s3, s3, 7
    s_add_u32 s5, s3, s10
    s_add_u32 m0, s87, 0
    s_nop 0
    buffer_load_dwordx4 v20, s[52:55], s5 offen offset:0 lds
    buffer_load_dwordx4 v21, s[52:55], s5 offen offset:1024 lds
    buffer_load_dwordx4 v22, s[52:55], s5 offen offset:2048 lds
    buffer_load_dwordx4 v23, s[52:55], s5 offen offset:3072 lds
    s_waitcnt vmcnt(17)
    s_barrier
    s_add_u32 s4, s4, s18
    s_add_u32 m0, s86, 49152
    s_nop 0
    buffer_load_dwordx4 v32, s[56:59], s4 offen offset:0 lds
    buffer_load_dwordx4 v33, s[56:59], s4 offen offset:1024 lds
    buffer_load_dwordx4 v34, s[56:59], s4 offen offset:2048 lds
    buffer_load_dwordx4 v35, s[56:59], s4 offen offset:3072 lds
    s_waitcnt vmcnt(13)
    s_barrier
    s_add_u32 s3, s101, 2
    s_and_b32 s3, s3, 3
    s_lshl_b32 s3, s3, 7
    s_add_u32 s5, s3, s10
    s_add_u32 m0, s87, 49152
    s_nop 0
    buffer_load_dwordx4 v20, s[52:55], s5 offen offset:0 lds
    buffer_load_dwordx4 v21, s[52:55], s5 offen offset:1024 lds
    buffer_load_dwordx4 v22, s[52:55], s5 offen offset:2048 lds
    buffer_load_dwordx4 v23, s[52:55], s5 offen offset:3072 lds
    v_mov_b32 v7, 0
    buffer_atomic_or v7, v1, s[60:63], s23 offen sc0 sc1
    v_lshlrev_b32 v5, 3, v2
    s_lshl_b32 s3, s69, 8
    v_add_u32 v5, s3, v5
    v_cmp_gt_u32 vcc, 32, v2
    v_mov_b32 v4, 0x80000000
    s_nop 0
    v_cndmask_b32 v5, v4, v5, vcc
    v_mov_b32 v4, 0
    buffer_atomic_or v4, v5, s[60:63], s97 offen sc1
    s_waitcnt vmcnt(14)
    s_barrier
    s_add_u32 s3, s101, 1
    s_and_b32 s3, s3, 3
    s_mul_i32 s4, s3, 57344
    s_add_u32 s4, s4, s90
    s_add_u32 m0, s86, 0
    s_nop 0
    buffer_load_dwordx4 v32, s[56:59], s4 offen offset:0 lds
    buffer_load_dwordx4 v33, s[56:59], s4 offen offset:1024 lds
    buffer_load_dwordx4 v34, s[56:59], s4 offen offset:2048 lds
    buffer_load_dwordx4 v35, s[56:59], s4 offen offset:3072 lds
    s_waitcnt vmcnt(5)
    v_readfirstlane_b32 s3, v7
    s_nop 0
    s_cmp_eq_u32 s3, s68
    s_cbranch_scc1 L_pok
    s_mov_b32 s98, 0
L_pspin:
    v_mov_b32 v7, 0
    buffer_atomic_or v7, v1, s[60:63], s23 offen sc0 sc1
    s_add_u32 s98, s98, 1
    s_cmp_gt_u32 s98, 200000
    s_cbranch_scc1 L_pok
    s_waitcnt vmcnt(0)
    v_readfirstlane_b32 s3, v7
    s_nop 0
    s_cmp_lg_u32 s3, s68
    s_cbranch_scc1 L_pspin
L_pok:
    s_lshl_b32 s3, s69, 12
    s_add_u32 m0, s3, 133120
    s_nop 0
    buffer_load_dwordx4 v2, s[60:63], s22 offen sc1 lds
    buffer_load_dwordx4 v2, s[60:63], s22 offen offset:1024 sc1 lds
    s_barrier
    s_add_u32 s4, s4, s18
    s_add_u32 m0, s86, 16384
    s_nop 0
    buffer_load_dwordx4 v32, s[56:59], s4 offen offset:0 lds
    buffer_load_dwordx4 v33, s[56:59], s4 offen offset:1024 lds
    buffer_load_dwordx4 v34, s[56:59], s4 offen offset:2048 lds
    buffer_load_dwordx4 v35, s[56:59], s4 offen offset:3072 lds
    s_add_u32 s3, s101, 3
    s_and_b32 s3, s3, 3
    s_lshl_b32 s3, s3, 7
    s_add_u32 s5, s3, s10
    s_add_u32 m0, s87, 32768
    s_nop 0
    buffer_load_dwordx4 v20, s[52:55], s5 offen offset:0 lds
    buffer_load_dwordx4 v21, s[52:55], s5 offen offset:1024 lds
    buffer_load_dwordx4 v22, s[52:55], s5 offen offset:2048 lds
    buffer_load_dwordx4 v23, s[52:55], s5 offen offset:3072 lds
    s_waitcnt vmcnt(10)
    s_barrier
    s_add_u32 s3, s101, 2
    s_and_b32 s3, s3, 3
    s_mul_i32 s4, s3, 57344
    s_add_u32 s4, s4, s90
    s_add_u32 m0, s86, 32768
    s_nop 0
    buffer_load_dwordx4 v32, s[56:59], s4 offen offset:0 lds
    buffer_load_dwordx4 v33, s[56:59], s4 offen offset:1024 lds
    buffer_load_dwordx4 v34, s[56:59], s4 offen offset:2048 lds
    buffer_load_dwordx4 v35, s[56:59], s4 offen offset:3072 lds
    s_waitcnt vmcnt(8)
    s_barrier
    s_add_u32 s4, s4, s18
    s_add_u32 m0, s86, 49152
    s_nop 0
    buffer_load_dwordx4 v32, s[56:59], s4 offen offset:0 lds
    buffer_load_dwordx4 v33, s[56:59], s4 offen offset:1024 lds
    buffer_load_dwordx4 v34, s[56:59], s4 offen offset:2048 lds
    buffer_load_dwordx4 v35, s[56:59], s4 offen offset:3072 lds
    s_waitcnt vmcnt(4)
    s_barrier
    s_add_u32 s3, s101, 3
    s_and_b32 s3, s3, 3
    s_mul_i32 s4, s3, 57344
    s_add_u32 s4, s4, s90
    s_add_u32 m0, s86, 0
    s_nop 0
    buffer_load_dwordx4 v32, s[56:59], s4 offen offset:0 lds
    buffer_load_dwordx4 v33, s[56:59], s4 offen offset:1024 lds
    buffer_load_dwordx4 v34, s[56:59], s4 offen offset:2048 lds
    buffer_load_dwordx4 v35, s[56:59], s4 offen offset:3072 lds
    s_add_u32 s4, s4, s18
    s_add_u32 m0, s86, 16384
    s_nop 0
    buffer_load_dwordx4 v32, s[56:59], s4 offen offset:0 lds
    buffer_load_dwordx4 v33, s[56:59], s4 offen offset:1024 lds
    buffer_load_dwordx4 v34, s[56:59], s4 offen offset:2048 lds
    buffer_load_dwordx4 v35, s[56:59], s4 offen offset:3072 lds
    s_waitcnt vmcnt(8)
    s_waitcnt lgkmcnt(0)
    s_barrier
    s_waitcnt vmcnt(0)
    s_barrier
L_join:
    s_waitcnt vmcnt(0)
    s_mov_b32 s11, 1
    s_branch L_sumv
L_dryback:
    s_barrier
    ds_read_b128 v[68:71], v13
    s_waitcnt lgkmcnt(0)
    v_lshlrev_b32 v72, 16, v68
    v_and_b32 v73, 0xffff0000, v68
    v_lshlrev_b32 v74, 16, v69
    v_and_b32 v75, 0xffff0000, v69
    v_lshlrev_b32 v76, 16, v70
    v_and_b32 v77, 0xffff0000, v70
    v_lshlrev_b32 v78, 16, v71
    v_and_b32 v79, 0xffff0000, v71
    s_add_u32 s12, s96, 0
    s_cmp_eq_u32 s95, 0
    s_cselect_b32 s12, 0x80000000, s12
    s_add_u32 s13, s96, 7168
    s_cmp_eq_u32 s95, 1
    s_cselect_b32 s13, 0x80000000, s13
    s_add_u32 s14, s96, 14336
    s_cmp_eq_u32 s95, 2
    s_cselect_b32 s14, 0x80000000, s14
    s_add_u32 s15, s96, 21504
    s_cmp_eq_u32 s95, 3
    s_cselect_b32 s15, 0x80000000, s15
    s_add_u32 s16, s96, 28672
    s_cmp_eq_u32 s95, 4
    s_cselect_b32 s16, 0x80000000, s16
    s_add_u32 s17, s96, 35840
    s_cmp_eq_u32 s95, 5
    s_cselect_b32 s17, 0x80000000, s17
    s_add_u32 s18, s96, 43008
    s_cmp_eq_u32 s95, 6
    s_cselect_b32 s18, 0x80000000, s18
    s_add_u32 s19, s96, 50176
    s_cmp_eq_u32 s95, 7
    s_cselect_b32 s19, 0x80000000, s19
    s_mov_b32 s11, 0
    s_mov_b32 s98, 0
    s_mov_b32 s10, s95
L_sum:
    s_barrier
    buffer_load_dwordx4 v[36:39], v2, s[60:63], s12 offen sc1
    buffer_load_dwordx4 v[40:43], v2, s[60:63], s13 offen sc1
    buffer_load_dwordx4 v[44:47], v2, s[60:63], s14 offen sc1
    buffer_load_dwordx4 v[48:51], v2, s[60:63], s15 offen sc1
    buffer_load_dwordx4 v[52:55], v2, s[60:63], s16 offen sc1
    buffer_load_dwordx4 v[56:59], v2, s[60:63], s17 offen sc1
    buffer_load_dwordx4 v[60:63], v2, s[60:63], s18 offen sc1
    buffer_load_dwordx4 v[64:67], v2, s[60:63], s19 offen sc1
L_sumv:
    s_waitcnt vmcnt(7)
    v_lshlrev_b32 v80, 16, v36
    v_and_b32 v81, 0xffff0000, v36
    v_pk_add_f32 v[72:73], v[72:73], v[80:81]
    v_lshlrev_b32 v80, 16, v37
    v_and_b32 v81, 0xffff0000, v37
    v_pk_add_f32 v[74:75], v[74:75], v[80:81]
    v_lshlrev_b32 v80, 16, v38
    v_and_b32 v81, 0xffff0000, v38
    v_pk_add_f32 v[76:77], v[76:77], v[80:81]
    v_lshlrev_b32 v80, 16, v39
    v_and_b32 v81, 0xffff0000, v39
    v_pk_add_f32 v[78:79], v[78:79], v[80:81]
    s_waitcnt vmcnt(6)
    v_lshlrev_b32 v80, 16, v40
    v_and_b32 v81, 0xffff0000, v40
    v_pk_add_f32 v[72:73], v[72:73], v[80:81]
    v_lshlrev_b32 v80, 16, v41
    v_and_b32 v81, 0xffff0000, v41
    v_pk_add_f32 v[74:75], v[74:75], v[80:81]
    v_lshlrev_b32 v80, 16, v42
    v_and_b32 v81, 0xffff0000, v42
    v_pk_add_f32 v[76:77], v[76:77], v[80:81]
    v_lshlrev_b32 v80, 16, v43
    v_and_b32 v81, 0xffff0000, v43
    v_pk_add_f32 v[78:79], v[78:79], v[80:81]
    s_waitcnt vmcnt(5)
    v_lshlrev_b32 v80, 16, v44
    v_and_b32 v81, 0xffff0000, v44
    v_pk_add_f32 v[72:73], v[72:73], v[80:81]
    v_lshlrev_b32 v80, 16, v45
    v_and_b32 v81, 0xffff0000, v45
    v_pk_add_f32 v[74:75], v[74:75], v[80:81]
    v_lshlrev_b32 v80, 16, v46
    v_and_b32 v81, 0xffff0000, v46
    v_pk_add_f32 v[76:77], v[76:77], v[80:81]
    v_lshlrev_b32 v80, 16, v47
    v_and_b32 v81, 0xffff0000, v47
    v_pk_add_f32 v[78:79], v[78:79], v[80:81]
    s_waitcnt vmcnt(4)
    v_lshlrev_b32 v80, 16, v48
    v_and_b32 v81, 0xffff0000, v48
    v_pk_add_f32 v[72:73], v[72:73], v[80:81]
    v_lshlrev_b32 v80, 16, v49
    v_and_b32 v81, 0xffff0000, v49
    v_pk_add_f32 v[74:75], v[74:75], v[80:81]
    v_lshlrev_b32 v80, 16, v50
    v_and_b32 v81, 0xffff0000, v50
    v_pk_add_f32 v[76:77], v[76:77], v[80:81]
    v_lshlrev_b32 v80, 16, v51
    v_and_b32 v81, 0xffff0000, v51
    v_pk_add_f32 v[78:79], v[78:79], v[80:81]
    s_waitcnt vmcnt(3)
    v_lshlrev_b32 v80, 16, v52
    v_and_b32 v81, 0xffff0000, v52
    v_pk_add_f32 v[72:73], v[72:73], v[80:81]
    v_lshlrev_b32 v80, 16, v53
    v_and_b32 v81, 0xffff0000, v53
    v_pk_add_f32 v[74:75], v[74:75], v[80:81]
    v_lshlrev_b32 v80, 16, v54
    v_and_b32 v81, 0xffff0000, v54
    v_pk_add_f32 v[76:77], v[76:77], v[80:81]
    v_lshlrev_b32 v80, 16, v55
    v_and_b32 v81, 0xffff0000, v55
    v_pk_add_f32 v[78:79], v[78:79], v[80:81]
    s_waitcnt vmcnt(2)
    v_lshlrev_b32 v80, 16, v56
    v_and_b32 v81, 0xffff0000, v56
    v_pk_add_f32 v[72:73], v[72:73], v[80:81]
    v_lshlrev_b32 v80, 16, v57
    v_and_b32 v81, 0xffff0000, v57
    v_pk_add_f32 v[74:75], v[74:75], v[80:81]
    v_lshlrev_b32 v80, 16, v58
    v_and_b32 v81, 0xffff0000, v58
    v_pk_add_f32 v[76:77], v[76:77], v[80:81]
    v_lshlrev_b32 v80, 16, v59
    v_and_b32 v81, 0xffff0000, v59
    v_pk_add_f32 v[78:79], v[78:79], v[80:81]
    s_waitcnt vmcnt(1)
    v_lshlrev_b32 v80, 16, v60
    v_and_b32 v81, 0xffff0000, v60
    v_pk_add_f32 v[72:73], v[72:73], v[80:81]
    v_lshlrev_b32 v80, 16, v61
    v_and_b32 v81, 0xffff0000, v61
    v_pk_add_f32 v[74:75], v[74:75], v[80:81]
    v_lshlrev_b32 v80, 16, v62
    v_and_b32 v81, 0xffff0000, v62
    v_pk_add_f32 v[76:77], v[76:77], v[80:81]
    v_lshlrev_b32 v80, 16, v63
    v_and_b32 v81, 0xffff0000, v63
    v_pk_add_f32 v[78:79], v[78:79], v[80:81]
    s_waitcnt vmcnt(0)
    v_lshlrev_b32 v80, 16, v64
    v_and_b32 v81, 0xffff0000, v64
    v_pk_add_f32 v[72:73], v[72:73], v[80:81]
    v_lshlrev_b32 v80, 16, v65
    v_and_b32 v81, 0xffff0000, v65
    v_pk_add_f32 v[74:75], v[74:75], v[80:81]
    v_lshlrev_b32 v80, 16, v66
    v_and_b32 v81, 0xffff0000, v66
    v_pk_add_f32 v[76:77], v[76:77], v[80:81]
    v_lshlrev_b32 v80, 16, v67
    v_and_b32 v81, 0xffff0000, v67
    v_pk_add_f32 v[78:79], v[78:79], v[80:81]
    v_cvt_pk_bf16_f32 v72, v72, v73
    v_cvt_pk_bf16_f32 v73, v74, v75
    v_cvt_pk_bf16_f32 v74, v76, v77
    v_cvt_pk_bf16_f32 v75, v78, v79
    s_cmp_lg_u32 s11, 0
    s_cbranch_scc1 L_dryback
    buffer_store_dwordx2 v[72:73], v12, s[64:67], s92 offen
    buffer_store_dwordx2 v[74:75], v12, s[64:67], s93 offen
    s_add_u32 s3, s35, s30
    s_cmp_lg_u32 s3, 4
    s_cbranch_scc1 L_fin
    s_cmp_lg_u32 s30, 4
    s_cbranch_scc1 L_fin
    v_mov_b32 v5, s68
    s_lshl_b32 s3, s31, 3
    s_add_u32 s3, s3, s33
    s_lshl_b32 s3, s3, 7
    buffer_store_dword v5, v1, s[60:63], s3 offen sc1
L_fin:
L_end:
    s_endpgm
L_mfma:
    v_lshrrev_b32 v4, 4, v2
    v_bfe_u32 v5, v2, 2, 2
    v_and_b32 v6, 3, v2
    v_and_b32 v7, 15, v2
    v_lshl_add_u32 v3, v4, 3, v5
    v_lshlrev_b32 v3, 9, v3
    v_lshl_add_u32 v3, v6, 3, v3
    v_lshl_add_u32 v3, v5, 5, v3
    v_and_b32 v0, 1, v4
    v_lshl_add_u32 v3, v0, 7, v3
    s_and_b32 s76, s30, 1
    s_lshr_b32 s77, s30, 1
    s_lshl_b32 s3, s77, 8
    s_add_u32 s78, s3, 0
    v_xor_b32 v8, s78, v3
    s_add_u32 s78, s3, 32
    v_xor_b32 v9, s78, v3
    s_add_u32 s78, s3, 64
    v_xor_b32 v10, s78, v3
    s_add_u32 s78, s3, 96
    v_xor_b32 v11, s78, v3
    s_add_u32 s78, s3, 128
    v_xor_b32 v12, s78, v3
    s_add_u32 s78, s3, 160
    v_xor_b32 v13, s78, v3
    s_add_u32 s78, s3, 192
    v_xor_b32 v14, s78, v3
    s_add_u32 s78, s3, 224
    v_xor_b32 v15, s78, v3
    v_lshrrev_b32 v0, 1, v7
    v_xor_b32 v0, v0, v4
    v_lshlrev_b32 v0, 4, v0
    v_lshl_add_u32 v0, v7, 7, v0
    s_lshl_b32 s78, s76, 13
    s_lshl_b32 s79, s77, 12
    s_add_u32 s78, s78, s79
    s_add_u32 s78, s78, 65536
    s_bfe_u32 s79, s33, 65538
    s_lshl_b32 s79, s79, 6
    v_xor_b32 v0, s79, v0
    v_add_u32 v16, s78, v0
    v_xor_b32 v17, 64, v16
    v_xor_b32 v18, 0x1000, v16
    v_xor_b32 v19, 0x1000, v17
    v_lshrrev_b32 v0, 1, v4
    v_xor_b32 v0, v0, v7
    v_lshlrev_b32 v0, 4, v0
    v_lshl_add_u32 v0, v7, 9, v0
    v_and_b32 v1, 1, v4
    v_lshl_add_u32 v0, v1, 3, v0
    s_lshl_b32 s78, s76, 15
    s_lshl_b32 s79, s77, 8
    s_add_u32 s78, s78, s79
    s_add_u32 s78, s78, 98304
    v_add_u32 v1, s78, v0
    v_lshlrev_b32 v2, 4, v2
    s_waitcnt lgkmcnt(0)
    s_add_u32 s60, s28, 0
    s_addc_u32 s61, s29, 0
    s_and_b32 s61, s61, 0xffff
    s_mov_b32 s62, 20971520
    s_mov_b32 s63, 0x20000
    s_mov_b32 s64, s24
    s_and_b32 s65, s25, 0xffff
    s_mov_b32 s66, 1835008
    s_mov_b32 s67, 0x20000
    s_lshl_b32 s3, s31, 3
    s_add_u32 s3, s3, s33
    s_lshl_b32 s3, s3, 7
    s_add_u32 s38, s60, s3
    s_addc_u32 s39, s61, 0
    s_load_dword s68, s[38:39], 0
    s_mov_b32 s22, s76
    s_mov_b32 s23, s77
    s_and_b32 s5, s34, 1
    s_lshl_b32 s5, s5, 6
    s_mul_i32 s44, s23, 224
    s_add_u32 s44, s44, s5
    s_add_u32 s45, s44, 32
    s_add_u32 s46, s44, 64
    s_add_u32 s47, s44, 96
    s_add_u32 s48, s44, 128
    s_add_u32 s49, s44, 160
    s_add_u32 s50, s44, 192
    s_lshl_b32 s52, s31, 3
    s_add_u32 s52, s52, s33
    s_lshl_b32 s52, s52, 1
    s_and_b32 s3, s34, 1
    s_add_u32 s52, s52, s3
    s_lshl_b32 s53, s32, 1
    s_lshr_b32 s3, s34, 1
    s_add_u32 s53, s53, s3
    s_lshl_b32 s4, s22, 2
    s_mul_i32 s5, s23, 3
    s_add_u32 s4, s4, s5
    s_xor_b32 s5, s4, 2
    s_lshl_b32 s3, s52, 3
    s_add_u32 s6, s4, s3
    s_add_u32 s7, s5, s3
    s_mul_i32 s3, s53, 7168
    s_add_u32 s3, s3, 4194304
    s_mul_i32 s54, s6, 57344
    s_add_u32 s54, s54, s3
    s_mul_i32 s55, s7, 57344
    s_add_u32 s55, s55, s3
    s_cmp_eq_u32 s4, s53
    s_cselect_b32 s54, 0x80000000, s54
    s_cselect_b32 s40, 0, 8192
    s_cmp_eq_u32 s5, s53
    s_cselect_b32 s55, 0x80000000, s55
    s_cselect_b32 s41, 0, 8192
    s_add_u32 s40, s40, 147456
    s_add_u32 s41, s41, 147456
    s_lshl_b32 s3, s53, 7
    s_add_u32 s3, s3, 262144
    s_lshl_b32 s56, s6, 10
    s_add_u32 s56, s56, s3
    s_lshl_b32 s57, s7, 10
    s_add_u32 s57, s57, s3
    s_lshl_b32 s4, s22, 1
    s_add_u32 s4, s4, s23
    s_lshl_b32 s21, s4, 12
    s_add_u32 s21, s21, 131072
    s_lshl_b32 s5, s23, 14
    s_add_u32 s20, s21, s5
    s_add_u32 s42, s30, 4
    s_lshl_b32 s3, s52, 3
    s_add_u32 s3, s3, s53
    s_lshl_b32 s97, s3, 10
    s_add_u32 s97, s97, 262144
    s_mul_i32 s96, s3, 57344
    s_add_u32 s96, s96, 4194304
    s_lshl_b32 s3, s42, 10
    s_add_u32 s96, s96, s3
    s_lshr_b32 s3, s53, 1
    s_lshl_b32 s92, s33, 2
    s_add_u32 s3, s3, s92
    s_mul_i32 s92, s3, 57344
    s_mul_i32 s3, s31, 896
    s_add_u32 s92, s92, s3
    s_and_b32 s3, s34, 1
    s_mul_i32 s3, s3, 448
    s_add_u32 s92, s92, s3
    s_and_b32 s3, s53, 1
    s_mul_i32 s3, s3, 224
    s_add_u32 s92, s92, s3
    s_lshl_b32 s3, s42, 5
    s_add_u32 s92, s92, s3
    s_add_u32 s93, s92, 28672
    s_mov_b64 exec, 0
    s_cmp_eq_u32 s30, 0
    s_cbranch_scc1 L_pg0
    s_cmp_eq_u32 s30, 1
    s_cbranch_scc1 L_pg1
    s_cmp_eq_u32 s30, 2
    s_cbranch_scc1 L_pg2
    s_branch L_pg3
L_pgback:
    s_mov_b64 exec, -1
    s_barrier
    ds_read_b64_tr_b16 v[20:21], v8 offset:0
    ds_read_b64_tr_b16 v[22:23], v8 offset:2048
    ds_read_b64_tr_b16 v[24:25], v9 offset:0
    ds_read_b64_tr_b16 v[26:27], v9 offset:2048
    ds_read_b128 v[36:39], v16 offset:0
    ds_read_b128 v[40:43], v16 offset:2048
    ds_read_b128 v[44:47], v18 offset:0
    ds_read_b128 v[48:51], v18 offset:2048
L_pg1:
    s_cbranch_execz L_pg5
    s_waitcnt lgkmcnt(3)
    v_mfma_f32_16x16x32_bf16 v[128:131], v[20:23], v[36:39], 0
    ds_read_b64_tr_b16 v[28:29], v10 offset:0
    s_waitcnt lgkmcnt(3)
    v_mfma_f32_16x16x32_bf16 v[132:135], v[20:23], v[40:43], 0
    ds_read_b64_tr_b16 v[30:31], v10 offset:2048
    s_waitcnt lgkmcnt(3)
    v_mfma_f32_16x16x32_bf16 v[136:139], v[20:23], v[44:47], 0
    s_waitcnt lgkmcnt(2)
    v_mfma_f32_16x16x32_bf16 v[140:143], v[20:23], v[48:51], 0
    v_mfma_f32_16x16x32_bf16 v[252:255], v[24:27], v[48:51], 0
    ds_read_b64_tr_b16 v[20:21], v11 offset:0
    v_mfma_f32_16x16x32_bf16 v[248:251], v[24:27], v[44:47], 0
    ds_read_b64_tr_b16 v[22:23], v11 offset:2048
    v_mfma_f32_16x16x32_bf16 v[244:247], v[24:27], v[40:43], 0
    v_mfma_f32_16x16x32_bf16 v[240:243], v[24:27], v[36:39], 0
    s_waitcnt lgkmcnt(2)
    v_mfma_f32_16x16x32_bf16 v[144:147], v[28:31], v[36:39], 0
    ds_read_b64_tr_b16 v[24:25], v12 offset:0
    v_mfma_f32_16x16x32_bf16 v[148:151], v[28:31], v[40:43], 0
    ds_read_b64_tr_b16 v[26:27], v12 offset:2048
    v_mfma_f32_16x16x32_bf16 v[152:155], v[28:31], v[44:47], 0
    v_mfma_f32_16x16x32_bf16 v[156:159], v[28:31], v[48:51], 0
    s_waitcnt lgkmcnt(2)
    v_mfma_f32_16x16x32_bf16 v[172:175], v[20:23], v[48:51], 0
    ds_read_b64_tr_b16 v[28:29], v13 offset:0
    v_mfma_f32_16x16x32_bf16 v[168:171], v[20:23], v[44:47], 0
    ds_read_b64_tr_b16 v[30:31], v13 offset:2048
    v_mfma_f32_16x16x32_bf16 v[164:167], v[20:23], v[40:43], 0
    v_mfma_f32_16x16x32_bf16 v[160:163], v[20:23], v[36:39], 0
    s_waitcnt lgkmcnt(2)
    v_mfma_f32_16x16x32_bf16 v[176:179], v[24:27], v[36:39], 0
    ds_read_b64_tr_b16 v[20:21], v14 offset:0
    v_mfma_f32_16x16x32_bf16 v[180:183], v[24:27], v[40:43], 0
    ds_read_b64_tr_b16 v[22:23], v14 offset:2048
    v_mfma_f32_16x16x32_bf16 v[184:187], v[24:27], v[44:47], 0
    v_mfma_f32_16x16x32_bf16 v[188:191], v[24:27], v[48:51], 0
    s_waitcnt lgkmcnt(2)
    v_mfma_f32_16x16x32_bf16 v[204:207], v[28:31], v[48:51], 0
    ds_read_b64_tr_b16 v[24:25], v15 offset:0
    v_mfma_f32_16x16x32_bf16 v[200:203], v[28:31], v[44:47], 0
    ds_read_b64_tr_b16 v[26:27], v15 offset:2048
    v_mfma_f32_16x16x32_bf16 v[196:199], v[28:31], v[40:43], 0
    v_mfma_f32_16x16x32_bf16 v[192:195], v[28:31], v[36:39], 0
    s_waitcnt lgkmcnt(0)
    s_barrier
    v_mfma_f32_16x16x32_bf16 v[208:211], v[20:23], v[36:39], 0
    ds_read_b64_tr_b16 v[28:29], v8 offset:16384
    ds_read_b128 v[52:55], v17 offset:0
    v_mfma_f32_16x16x32_bf16 v[212:215], v[20:23], v[40:43], 0
    ds_read_b64_tr_b16 v[30:31], v8 offset:18432
    ds_read_b128 v[56:59], v17 offset:2048
    v_mfma_f32_16x16x32_bf16 v[216:219], v[20:23], v[44:47], 0
    ds_read_b128 v[60:63], v19 offset:0
    v_mfma_f32_16x16x32_bf16 v[220:223], v[20:23], v[48:51], 0
    ds_read_b128 v[64:67], v19 offset:2048
    v_mfma_f32_16x16x32_bf16 v[236:239], v[24:27], v[48:51], 0
    ds_read_b64_tr_b16 v[20:21], v9 offset:16384
    v_mfma_f32_16x16x32_bf16 v[232:235], v[24:27], v[44:47], 0
    ds_read_b64_tr_b16 v[22:23], v9 offset:18432
    v_mfma_f32_16x16x32_bf16 v[228:231], v[24:27], v[40:43], 0
    v_mfma_f32_16x16x32_bf16 v[224:227], v[24:27], v[36:39], 0
    s_waitcnt lgkmcnt(5)
    v_mfma_f32_16x16x32_bf16 v[128:131], v[28:31], v[52:55], v[128:131]
    ds_read_b64_tr_b16 v[24:25], v10 offset:16384
    s_waitcnt lgkmcnt(5)
    v_mfma_f32_16x16x32_bf16 v[132:135], v[28:31], v[56:59], v[132:135]
    ds_read_b64_tr_b16 v[26:27], v10 offset:18432
    s_waitcnt lgkmcnt(5)
    v_mfma_f32_16x16x32_bf16 v[136:139], v[28:31], v[60:63], v[136:139]
    s_waitcnt lgkmcnt(4)
    v_mfma_f32_16x16x32_bf16 v[140:143], v[28:31], v[64:67], v[140:143]
    s_waitcnt lgkmcnt(2)
    v_mfma_f32_16x16x32_bf16 v[252:255], v[20:23], v[64:67], v[252:255]
    ds_read_b64_tr_b16 v[28:29], v11 offset:16384
    v_mfma_f32_16x16x32_bf16 v[248:251], v[20:23], v[60:63], v[248:251]
    ds_read_b64_tr_b16 v[30:31], v11 offset:18432
    v_mfma_f32_16x16x32_bf16 v[244:247], v[20:23], v[56:59], v[244:247]
    v_mfma_f32_16x16x32_bf16 v[240:243], v[20:23], v[52:55], v[240:243]
    s_waitcnt lgkmcnt(2)
    v_mfma_f32_16x16x32_bf16 v[144:147], v[24:27], v[52:55], v[144:147]
    ds_read_b64_tr_b16 v[20:21], v12 offset:16384
    v_mfma_f32_16x16x32_bf16 v[148:151], v[24:27], v[56:59], v[148:151]
    ds_read_b64_tr_b16 v[22:23], v12 offset:18432
    v_mfma_f32_16x16x32_bf16 v[152:155], v[24:27], v[60:63], v[152:155]
    v_mfma_f32_16x16x32_bf16 v[156:159], v[24:27], v[64:67], v[156:159]
    s_waitcnt lgkmcnt(2)
    v_mfma_f32_16x16x32_bf16 v[172:175], v[28:31], v[64:67], v[172:175]
    ds_read_b64_tr_b16 v[24:25], v13 offset:16384
    v_mfma_f32_16x16x32_bf16 v[168:171], v[28:31], v[60:63], v[168:171]
    ds_read_b64_tr_b16 v[26:27], v13 offset:18432
    v_mfma_f32_16x16x32_bf16 v[164:167], v[28:31], v[56:59], v[164:167]
    v_mfma_f32_16x16x32_bf16 v[160:163], v[28:31], v[52:55], v[160:163]
    s_waitcnt lgkmcnt(2)
    v_mfma_f32_16x16x32_bf16 v[176:179], v[20:23], v[52:55], v[176:179]
    ds_read_b64_tr_b16 v[28:29], v14 offset:16384
    v_mfma_f32_16x16x32_bf16 v[180:183], v[20:23], v[56:59], v[180:183]
    ds_read_b64_tr_b16 v[30:31], v14 offset:18432
    v_mfma_f32_16x16x32_bf16 v[184:187], v[20:23], v[60:63], v[184:187]
    v_mfma_f32_16x16x32_bf16 v[188:191], v[20:23], v[64:67], v[188:191]
    s_waitcnt lgkmcnt(2)
    v_mfma_f32_16x16x32_bf16 v[204:207], v[24:27], v[64:67], v[204:207]
    ds_read_b64_tr_b16 v[20:21], v15 offset:16384
    v_mfma_f32_16x16x32_bf16 v[200:203], v[24:27], v[60:63], v[200:203]
    ds_read_b64_tr_b16 v[22:23], v15 offset:18432
    v_mfma_f32_16x16x32_bf16 v[196:199], v[24:27], v[56:59], v[196:199]
    v_mfma_f32_16x16x32_bf16 v[192:195], v[24:27], v[52:55], v[192:195]
    s_waitcnt lgkmcnt(0)
    s_barrier
    v_mfma_f32_16x16x32_bf16 v[208:211], v[28:31], v[52:55], v[208:211]
    ds_read_b64_tr_b16 v[24:25], v8 offset:32768
    ds_read_b128 v[36:39], v16 offset:16384
    v_mfma_f32_16x16x32_bf16 v[212:215], v[28:31], v[56:59], v[212:215]
    ds_read_b64_tr_b16 v[26:27], v8 offset:34816
    ds_read_b128 v[40:43], v16 offset:18432
    v_mfma_f32_16x16x32_bf16 v[216:219], v[28:31], v[60:63], v[216:219]
    ds_read_b128 v[44:47], v18 offset:16384
    v_mfma_f32_16x16x32_bf16 v[220:223], v[28:31], v[64:67], v[220:223]
    ds_read_b128 v[48:51], v18 offset:18432
    v_mfma_f32_16x16x32_bf16 v[236:239], v[20:23], v[64:67], v[236:239]
    ds_read_b64_tr_b16 v[28:29], v9 offset:32768
    v_mfma_f32_16x16x32_bf16 v[232:235], v[20:23], v[60:63], v[232:235]
    ds_read_b64_tr_b16 v[30:31], v9 offset:34816
    v_mfma_f32_16x16x32_bf16 v[228:231], v[20:23], v[56:59], v[228:231]
    v_mfma_f32_16x16x32_bf16 v[224:227], v[20:23], v[52:55], v[224:227]
    s_waitcnt lgkmcnt(5)
    v_mfma_f32_16x16x32_bf16 v[128:131], v[24:27], v[36:39], v[128:131]
    ds_read_b64_tr_b16 v[20:21], v10 offset:32768
    s_waitcnt lgkmcnt(5)
    v_mfma_f32_16x16x32_bf16 v[132:135], v[24:27], v[40:43], v[132:135]
    ds_read_b64_tr_b16 v[22:23], v10 offset:34816
    s_waitcnt lgkmcnt(5)
    v_mfma_f32_16x16x32_bf16 v[136:139], v[24:27], v[44:47], v[136:139]
    s_waitcnt lgkmcnt(4)
    v_mfma_f32_16x16x32_bf16 v[140:143], v[24:27], v[48:51], v[140:143]
    s_waitcnt lgkmcnt(2)
    v_mfma_f32_16x16x32_bf16 v[252:255], v[28:31], v[48:51], v[252:255]
    ds_read_b64_tr_b16 v[24:25], v11 offset:32768
    v_mfma_f32_16x16x32_bf16 v[248:251], v[28:31], v[44:47], v[248:251]
    ds_read_b64_tr_b16 v[26:27], v11 offset:34816
    v_mfma_f32_16x16x32_bf16 v[244:247], v[28:31], v[40:43], v[244:247]
    v_mfma_f32_16x16x32_bf16 v[240:243], v[28:31], v[36:39], v[240:243]
    s_waitcnt lgkmcnt(2)
    v_mfma_f32_16x16x32_bf16 v[144:147], v[20:23], v[36:39], v[144:147]
    ds_read_b64_tr_b16 v[28:29], v12 offset:32768
    v_mfma_f32_16x16x32_bf16 v[148:151], v[20:23], v[40:43], v[148:151]
    ds_read_b64_tr_b16 v[30:31], v12 offset:34816
    v_mfma_f32_16x16x32_bf16 v[152:155], v[20:23], v[44:47], v[152:155]
    v_mfma_f32_16x16x32_bf16 v[156:159], v[20:23], v[48:51], v[156:159]
    s_waitcnt lgkmcnt(2)
    v_mfma_f32_16x16x32_bf16 v[172:175], v[24:27], v[48:51], v[172:175]
    ds_read_b64_tr_b16 v[20:21], v13 offset:32768
    v_mfma_f32_16x16x32_bf16 v[168:171], v[24:27], v[44:47], v[168:171]
    ds_read_b64_tr_b16 v[22:23], v13 offset:34816
    v_mfma_f32_16x16x32_bf16 v[164:167], v[24:27], v[40:43], v[164:167]
    v_mfma_f32_16x16x32_bf16 v[160:163], v[24:27], v[36:39], v[160:163]
    s_waitcnt lgkmcnt(2)
    v_mfma_f32_16x16x32_bf16 v[176:179], v[28:31], v[36:39], v[176:179]
    ds_read_b64_tr_b16 v[24:25], v14 offset:32768
    v_mfma_f32_16x16x32_bf16 v[180:183], v[28:31], v[40:43], v[180:183]
    ds_read_b64_tr_b16 v[26:27], v14 offset:34816
    v_mfma_f32_16x16x32_bf16 v[184:187], v[28:31], v[44:47], v[184:187]
    v_mfma_f32_16x16x32_bf16 v[188:191], v[28:31], v[48:51], v[188:191]
    s_waitcnt lgkmcnt(2)
    v_mfma_f32_16x16x32_bf16 v[204:207], v[20:23], v[48:51], v[204:207]
    ds_read_b64_tr_b16 v[28:29], v15 offset:32768
    v_mfma_f32_16x16x32_bf16 v[200:203], v[20:23], v[44:47], v[200:203]
    ds_read_b64_tr_b16 v[30:31], v15 offset:34816
    v_mfma_f32_16x16x32_bf16 v[196:199], v[20:23], v[40:43], v[196:199]
    v_mfma_f32_16x16x32_bf16 v[192:195], v[20:23], v[36:39], v[192:195]
    s_waitcnt lgkmcnt(0)
    s_barrier
    v_mfma_f32_16x16x32_bf16 v[208:211], v[24:27], v[36:39], v[208:211]
    ds_read_b64_tr_b16 v[20:21], v8 offset:49152
    ds_read_b128 v[52:55], v17 offset:16384
    v_mfma_f32_16x16x32_bf16 v[212:215], v[24:27], v[40:43], v[212:215]
    ds_read_b64_tr_b16 v[22:23], v8 offset:51200
    ds_read_b128 v[56:59], v17 offset:18432
    v_mfma_f32_16x16x32_bf16 v[216:219], v[24:27], v[44:47], v[216:219]
    ds_read_b128 v[60:63], v19 offset:16384
    v_mfma_f32_16x16x32_bf16 v[220:223], v[24:27], v[48:51], v[220:223]
    ds_read_b128 v[64:67], v19 offset:18432
    v_mfma_f32_16x16x32_bf16 v[236:239], v[28:31], v[48:51], v[236:239]
    ds_read_b64_tr_b16 v[24:25], v9 offset:49152
    v_mfma_f32_16x16x32_bf16 v[232:235], v[28:31], v[44:47], v[232:235]
    ds_read_b64_tr_b16 v[26:27], v9 offset:51200
    v_mfma_f32_16x16x32_bf16 v[228:231], v[28:31], v[40:43], v[228:231]
    v_mfma_f32_16x16x32_bf16 v[224:227], v[28:31], v[36:39], v[224:227]
    s_waitcnt lgkmcnt(5)
    v_mfma_f32_16x16x32_bf16 v[128:131], v[20:23], v[52:55], v[128:131]
    ds_read_b64_tr_b16 v[28:29], v10 offset:49152
    s_waitcnt lgkmcnt(5)
    v_mfma_f32_16x16x32_bf16 v[132:135], v[20:23], v[56:59], v[132:135]
    ds_read_b64_tr_b16 v[30:31], v10 offset:51200
    s_waitcnt lgkmcnt(5)
    v_mfma_f32_16x16x32_bf16 v[136:139], v[20:23], v[60:63], v[136:139]
    s_waitcnt lgkmcnt(4)
    v_mfma_f32_16x16x32_bf16 v[140:143], v[20:23], v[64:67], v[140:143]
    s_waitcnt lgkmcnt(2)
    v_mfma_f32_16x16x32_bf16 v[252:255], v[24:27], v[64:67], v[252:255]
    ds_read_b64_tr_b16 v[20:21], v11 offset:49152
    v_mfma_f32_16x16x32_bf16 v[248:251], v[24:27], v[60:63], v[248:251]
    ds_read_b64_tr_b16 v[22:23], v11 offset:51200
    v_mfma_f32_16x16x32_bf16 v[244:247], v[24:27], v[56:59], v[244:247]
    v_mfma_f32_16x16x32_bf16 v[240:243], v[24:27], v[52:55], v[240:243]
    s_waitcnt lgkmcnt(2)
    v_mfma_f32_16x16x32_bf16 v[144:147], v[28:31], v[52:55], v[144:147]
    ds_read_b64_tr_b16 v[24:25], v12 offset:49152
    v_mfma_f32_16x16x32_bf16 v[148:151], v[28:31], v[56:59], v[148:151]
    ds_read_b64_tr_b16 v[26:27], v12 offset:51200
    v_mfma_f32_16x16x32_bf16 v[152:155], v[28:31], v[60:63], v[152:155]
    v_mfma_f32_16x16x32_bf16 v[156:159], v[28:31], v[64:67], v[156:159]
    s_waitcnt lgkmcnt(2)
    v_mfma_f32_16x16x32_bf16 v[172:175], v[20:23], v[64:67], v[172:175]
    ds_read_b64_tr_b16 v[28:29], v13 offset:49152
    v_mfma_f32_16x16x32_bf16 v[168:171], v[20:23], v[60:63], v[168:171]
    ds_read_b64_tr_b16 v[30:31], v13 offset:51200
    v_mfma_f32_16x16x32_bf16 v[164:167], v[20:23], v[56:59], v[164:167]
    v_mfma_f32_16x16x32_bf16 v[160:163], v[20:23], v[52:55], v[160:163]
    s_waitcnt lgkmcnt(2)
    v_mfma_f32_16x16x32_bf16 v[176:179], v[24:27], v[52:55], v[176:179]
    ds_read_b64_tr_b16 v[20:21], v14 offset:49152
    v_mfma_f32_16x16x32_bf16 v[180:183], v[24:27], v[56:59], v[180:183]
    ds_read_b64_tr_b16 v[22:23], v14 offset:51200
    v_mfma_f32_16x16x32_bf16 v[184:187], v[24:27], v[60:63], v[184:187]
    v_mfma_f32_16x16x32_bf16 v[188:191], v[24:27], v[64:67], v[188:191]
    s_waitcnt lgkmcnt(2)
    v_mfma_f32_16x16x32_bf16 v[204:207], v[28:31], v[64:67], v[204:207]
    ds_read_b64_tr_b16 v[24:25], v15 offset:49152
    v_mfma_f32_16x16x32_bf16 v[200:203], v[28:31], v[60:63], v[200:203]
    ds_read_b64_tr_b16 v[26:27], v15 offset:51200
    v_mfma_f32_16x16x32_bf16 v[196:199], v[28:31], v[56:59], v[196:199]
    v_mfma_f32_16x16x32_bf16 v[192:195], v[28:31], v[52:55], v[192:195]
    s_waitcnt lgkmcnt(0)
    s_barrier
    v_mfma_f32_16x16x32_bf16 v[208:211], v[20:23], v[52:55], v[208:211]
    ds_read_b64_tr_b16 v[28:29], v8 offset:0
    ds_read_b128 v[36:39], v16 offset:0
    v_mfma_f32_16x16x32_bf16 v[212:215], v[20:23], v[56:59], v[212:215]
    ds_read_b64_tr_b16 v[30:31], v8 offset:2048
    ds_read_b128 v[40:43], v16 offset:2048
    v_mfma_f32_16x16x32_bf16 v[216:219], v[20:23], v[60:63], v[216:219]
    ds_read_b128 v[44:47], v18 offset:0
    v_mfma_f32_16x16x32_bf16 v[220:223], v[20:23], v[64:67], v[220:223]
    ds_read_b128 v[48:51], v18 offset:2048
    v_mfma_f32_16x16x32_bf16 v[236:239], v[24:27], v[64:67], v[236:239]
    ds_read_b64_tr_b16 v[20:21], v9 offset:0
    v_mfma_f32_16x16x32_bf16 v[232:235], v[24:27], v[60:63], v[232:235]
    ds_read_b64_tr_b16 v[22:23], v9 offset:2048
    v_mfma_f32_16x16x32_bf16 v[228:231], v[24:27], v[56:59], v[228:231]
    v_mfma_f32_16x16x32_bf16 v[224:227], v[24:27], v[52:55], v[224:227]
    s_waitcnt lgkmcnt(5)
    v_mfma_f32_16x16x32_bf16 v[128:131], v[28:31], v[36:39], v[128:131]
    ds_read_b64_tr_b16 v[24:25], v10 offset:0
    s_waitcnt lgkmcnt(5)
    v_mfma_f32_16x16x32_bf16 v[132:135], v[28:31], v[40:43], v[132:135]
    ds_read_b64_tr_b16 v[26:27], v10 offset:2048
    s_waitcnt lgkmcnt(5)
    v_mfma_f32_16x16x32_bf16 v[136:139], v[28:31], v[44:47], v[136:139]
    s_waitcnt lgkmcnt(4)
    v_mfma_f32_16x16x32_bf16 v[140:143], v[28:31], v[48:51], v[140:143]
    s_waitcnt lgkmcnt(2)
    v_mfma_f32_16x16x32_bf16 v[252:255], v[20:23], v[48:51], v[252:255]
    ds_read_b64_tr_b16 v[28:29], v11 offset:0
    v_mfma_f32_16x16x32_bf16 v[248:251], v[20:23], v[44:47], v[248:251]
    ds_read_b64_tr_b16 v[30:31], v11 offset:2048
    v_mfma_f32_16x16x32_bf16 v[244:247], v[20:23], v[40:43], v[244:247]
    v_mfma_f32_16x16x32_bf16 v[240:243], v[20:23], v[36:39], v[240:243]
    s_waitcnt lgkmcnt(2)
    v_mfma_f32_16x16x32_bf16 v[144:147], v[24:27], v[36:39], v[144:147]
    ds_read_b64_tr_b16 v[20:21], v12 offset:0
    v_mfma_f32_16x16x32_bf16 v[148:151], v[24:27], v[40:43], v[148:151]
    ds_read_b64_tr_b16 v[22:23], v12 offset:2048
    v_mfma_f32_16x16x32_bf16 v[152:155], v[24:27], v[44:47], v[152:155]
    v_mfma_f32_16x16x32_bf16 v[156:159], v[24:27], v[48:51], v[156:159]
    s_waitcnt lgkmcnt(2)
    v_mfma_f32_16x16x32_bf16 v[172:175], v[28:31], v[48:51], v[172:175]
    ds_read_b64_tr_b16 v[24:25], v13 offset:0
    v_mfma_f32_16x16x32_bf16 v[168:171], v[28:31], v[44:47], v[168:171]
    ds_read_b64_tr_b16 v[26:27], v13 offset:2048
    v_mfma_f32_16x16x32_bf16 v[164:167], v[28:31], v[40:43], v[164:167]
    v_mfma_f32_16x16x32_bf16 v[160:163], v[28:31], v[36:39], v[160:163]
    s_waitcnt lgkmcnt(2)
    v_mfma_f32_16x16x32_bf16 v[176:179], v[20:23], v[36:39], v[176:179]
    ds_read_b64_tr_b16 v[28:29], v14 offset:0
    v_mfma_f32_16x16x32_bf16 v[180:183], v[20:23], v[40:43], v[180:183]
    ds_read_b64_tr_b16 v[30:31], v14 offset:2048
    v_mfma_f32_16x16x32_bf16 v[184:187], v[20:23], v[44:47], v[184:187]
    v_mfma_f32_16x16x32_bf16 v[188:191], v[20:23], v[48:51], v[188:191]
    s_waitcnt lgkmcnt(2)
    v_mfma_f32_16x16x32_bf16 v[204:207], v[24:27], v[48:51], v[204:207]
    ds_read_b64_tr_b16 v[20:21], v15 offset:0
    v_mfma_f32_16x16x32_bf16 v[200:203], v[24:27], v[44:47], v[200:203]
    ds_read_b64_tr_b16 v[22:23], v15 offset:2048
    v_mfma_f32_16x16x32_bf16 v[196:199], v[24:27], v[40:43], v[196:199]
    v_mfma_f32_16x16x32_bf16 v[192:195], v[24:27], v[36:39], v[192:195]
    s_waitcnt lgkmcnt(0)
    s_barrier
    v_mfma_f32_16x16x32_bf16 v[208:211], v[28:31], v[36:39], v[208:211]
    ds_read_b64_tr_b16 v[24:25], v8 offset:16384
    ds_read_b128 v[52:55], v17 offset:0
    v_mfma_f32_16x16x32_bf16 v[212:215], v[28:31], v[40:43], v[212:215]
    ds_read_b64_tr_b16 v[26:27], v8 offset:18432
    ds_read_b128 v[56:59], v17 offset:2048
    v_mfma_f32_16x16x32_bf16 v[216:219], v[28:31], v[44:47], v[216:219]
    ds_read_b128 v[60:63], v19 offset:0
    v_mfma_f32_16x16x32_bf16 v[220:223], v[28:31], v[48:51], v[220:223]
    ds_read_b128 v[64:67], v19 offset:2048
    v_mfma_f32_16x16x32_bf16 v[236:239], v[20:23], v[48:51], v[236:239]
    ds_read_b64_tr_b16 v[28:29], v9 offset:16384
    v_mfma_f32_16x16x32_bf16 v[232:235], v[20:23], v[44:47], v[232:235]
    ds_read_b64_tr_b16 v[30:31], v9 offset:18432
    v_mfma_f32_16x16x32_bf16 v[228:231], v[20:23], v[40:43], v[228:231]
    v_mfma_f32_16x16x32_bf16 v[224:227], v[20:23], v[36:39], v[224:227]
    s_waitcnt lgkmcnt(5)
    v_mfma_f32_16x16x32_bf16 v[128:131], v[24:27], v[52:55], v[128:131]
    ds_read_b64_tr_b16 v[20:21], v10 offset:16384
    s_waitcnt lgkmcnt(5)
    v_mfma_f32_16x16x32_bf16 v[132:135], v[24:27], v[56:59], v[132:135]
    ds_read_b64_tr_b16 v[22:23], v10 offset:18432
    s_waitcnt lgkmcnt(5)
    v_mfma_f32_16x16x32_bf16 v[136:139], v[24:27], v[60:63], v[136:139]
    s_waitcnt lgkmcnt(4)
    v_mfma_f32_16x16x32_bf16 v[140:143], v[24:27], v[64:67], v[140:143]
    s_waitcnt lgkmcnt(2)
    v_mfma_f32_16x16x32_bf16 v[252:255], v[28:31], v[64:67], v[252:255]
    ds_read_b64_tr_b16 v[24:25], v11 offset:16384
    v_mfma_f32_16x16x32_bf16 v[248:251], v[28:31], v[60:63], v[248:251]
    ds_read_b64_tr_b16 v[26:27], v11 offset:18432
    v_mfma_f32_16x16x32_bf16 v[244:247], v[28:31], v[56:59], v[244:247]
    v_mfma_f32_16x16x32_bf16 v[240:243], v[28:31], v[52:55], v[240:243]
    s_waitcnt lgkmcnt(2)
    v_mfma_f32_16x16x32_bf16 v[144:147], v[20:23], v[52:55], v[144:147]
    ds_read_b64_tr_b16 v[28:29], v12 offset:16384
    v_mfma_f32_16x16x32_bf16 v[148:151], v[20:23], v[56:59], v[148:151]
    ds_read_b64_tr_b16 v[30:31], v12 offset:18432
    v_mfma_f32_16x16x32_bf16 v[152:155], v[20:23], v[60:63], v[152:155]
    v_mfma_f32_16x16x32_bf16 v[156:159], v[20:23], v[64:67], v[156:159]
    s_waitcnt lgkmcnt(2)
    v_mfma_f32_16x16x32_bf16 v[172:175], v[24:27], v[64:67], v[172:175]
    ds_read_b64_tr_b16 v[20:21], v13 offset:16384
    v_mfma_f32_16x16x32_bf16 v[168:171], v[24:27], v[60:63], v[168:171]
    ds_read_b64_tr_b16 v[22:23], v13 offset:18432
    v_mfma_f32_16x16x32_bf16 v[164:167], v[24:27], v[56:59], v[164:167]
    v_mfma_f32_16x16x32_bf16 v[160:163], v[24:27], v[52:55], v[160:163]
    s_waitcnt lgkmcnt(2)
    v_mfma_f32_16x16x32_bf16 v[176:179], v[28:31], v[52:55], v[176:179]
    ds_read_b64_tr_b16 v[24:25], v14 offset:16384
    v_mfma_f32_16x16x32_bf16 v[180:183], v[28:31], v[56:59], v[180:183]
    ds_read_b64_tr_b16 v[26:27], v14 offset:18432
    v_mfma_f32_16x16x32_bf16 v[184:187], v[28:31], v[60:63], v[184:187]
    v_mfma_f32_16x16x32_bf16 v[188:191], v[28:31], v[64:67], v[188:191]
    s_waitcnt lgkmcnt(2)
    v_mfma_f32_16x16x32_bf16 v[204:207], v[20:23], v[64:67], v[204:207]
    ds_read_b64_tr_b16 v[28:29], v15 offset:16384
    v_mfma_f32_16x16x32_bf16 v[200:203], v[20:23], v[60:63], v[200:203]
    ds_read_b64_tr_b16 v[30:31], v15 offset:18432
    v_mfma_f32_16x16x32_bf16 v[196:199], v[20:23], v[56:59], v[196:199]
    v_mfma_f32_16x16x32_bf16 v[192:195], v[20:23], v[52:55], v[192:195]
    s_waitcnt lgkmcnt(0)
    s_add_u32 s68, s68, 0x9E3779B9
    s_barrier
    v_mfma_f32_16x16x32_bf16 v[208:211], v[24:27], v[52:55], v[208:211]
    ds_read_b64_tr_b16 v[20:21], v8 offset:32768
    ds_read_b128 v[36:39], v16 offset:16384
    v_mfma_f32_16x16x32_bf16 v[212:215], v[24:27], v[56:59], v[212:215]
    ds_read_b64_tr_b16 v[22:23], v8 offset:34816
    ds_read_b128 v[40:43], v16 offset:18432
    v_mfma_f32_16x16x32_bf16 v[216:219], v[24:27], v[60:63], v[216:219]
    ds_read_b128 v[44:47], v18 offset:16384
    v_mfma_f32_16x16x32_bf16 v[220:223], v[24:27], v[64:67], v[220:223]
    ds_read_b128 v[48:51], v18 offset:18432
    v_mfma_f32_16x16x32_bf16 v[236:239], v[28:31], v[64:67], v[236:239]
    ds_read_b64_tr_b16 v[24:25], v9 offset:32768
    v_mfma_f32_16x16x32_bf16 v[232:235], v[28:31], v[60:63], v[232:235]
    ds_read_b64_tr_b16 v[26:27], v9 offset:34816
    v_mfma_f32_16x16x32_bf16 v[228:231], v[28:31], v[56:59], v[228:231]
    v_mfma_f32_16x16x32_bf16 v[224:227], v[28:31], v[52:55], v[224:227]
    s_waitcnt lgkmcnt(5)
    v_mfma_f32_16x16x32_bf16 v[128:131], v[20:23], v[36:39], v[128:131]
    ds_read_b64_tr_b16 v[28:29], v10 offset:32768
    s_waitcnt lgkmcnt(5)
    v_mfma_f32_16x16x32_bf16 v[132:135], v[20:23], v[40:43], v[132:135]
    ds_read_b64_tr_b16 v[30:31], v10 offset:34816
    s_waitcnt lgkmcnt(5)
    v_mfma_f32_16x16x32_bf16 v[136:139], v[20:23], v[44:47], v[136:139]
    s_waitcnt lgkmcnt(4)
    v_mfma_f32_16x16x32_bf16 v[140:143], v[20:23], v[48:51], v[140:143]
    s_waitcnt lgkmcnt(2)
    v_mfma_f32_16x16x32_bf16 v[252:255], v[24:27], v[48:51], v[252:255]
    ds_read_b64_tr_b16 v[20:21], v11 offset:32768
    v_mfma_f32_16x16x32_bf16 v[248:251], v[24:27], v[44:47], v[248:251]
    ds_read_b64_tr_b16 v[22:23], v11 offset:34816
    v_mfma_f32_16x16x32_bf16 v[244:247], v[24:27], v[40:43], v[244:247]
    v_mfma_f32_16x16x32_bf16 v[240:243], v[24:27], v[36:39], v[240:243]
    s_waitcnt lgkmcnt(2)
    v_mfma_f32_16x16x32_bf16 v[144:147], v[28:31], v[36:39], v[144:147]
    ds_read_b64_tr_b16 v[24:25], v12 offset:32768
    v_mfma_f32_16x16x32_bf16 v[148:151], v[28:31], v[40:43], v[148:151]
    ds_read_b64_tr_b16 v[26:27], v12 offset:34816
    v_mfma_f32_16x16x32_bf16 v[152:155], v[28:31], v[44:47], v[152:155]
    v_mfma_f32_16x16x32_bf16 v[156:159], v[28:31], v[48:51], v[156:159]
    s_waitcnt lgkmcnt(2)
    v_mfma_f32_16x16x32_bf16 v[172:175], v[20:23], v[48:51], v[172:175]
    ds_read_b64_tr_b16 v[28:29], v13 offset:32768
    v_mfma_f32_16x16x32_bf16 v[168:171], v[20:23], v[44:47], v[168:171]
    ds_read_b64_tr_b16 v[30:31], v13 offset:34816
    v_mfma_f32_16x16x32_bf16 v[164:167], v[20:23], v[40:43], v[164:167]
    v_mfma_f32_16x16x32_bf16 v[160:163], v[20:23], v[36:39], v[160:163]
    s_waitcnt lgkmcnt(2)
    v_mfma_f32_16x16x32_bf16 v[176:179], v[24:27], v[36:39], v[176:179]
    ds_read_b64_tr_b16 v[20:21], v14 offset:32768
    v_mfma_f32_16x16x32_bf16 v[180:183], v[24:27], v[40:43], v[180:183]
    ds_read_b64_tr_b16 v[22:23], v14 offset:34816
    v_mfma_f32_16x16x32_bf16 v[184:187], v[24:27], v[44:47], v[184:187]
    v_mfma_f32_16x16x32_bf16 v[188:191], v[24:27], v[48:51], v[188:191]
    s_waitcnt lgkmcnt(2)
    v_mfma_f32_16x16x32_bf16 v[204:207], v[28:31], v[48:51], v[204:207]
    ds_read_b64_tr_b16 v[24:25], v15 offset:32768
    v_mfma_f32_16x16x32_bf16 v[200:203], v[28:31], v[44:47], v[200:203]
    ds_read_b64_tr_b16 v[26:27], v15 offset:34816
    v_mfma_f32_16x16x32_bf16 v[196:199], v[28:31], v[40:43], v[196:199]
    v_mfma_f32_16x16x32_bf16 v[192:195], v[28:31], v[36:39], v[192:195]
    s_waitcnt lgkmcnt(0)
    s_barrier
    v_mfma_f32_16x16x32_bf16 v[208:211], v[20:23], v[36:39], v[208:211]
    ds_read_b64_tr_b16 v[28:29], v8 offset:49152
    ds_read_b128 v[52:55], v17 offset:16384
    v_mfma_f32_16x16x32_bf16 v[212:215], v[20:23], v[40:43], v[212:215]
    ds_read_b64_tr_b16 v[30:31], v8 offset:51200
    ds_read_b128 v[56:59], v17 offset:18432
    v_mfma_f32_16x16x32_bf16 v[216:219], v[20:23], v[44:47], v[216:219]
    ds_read_b128 v[60:63], v19 offset:16384
    v_mfma_f32_16x16x32_bf16 v[220:223], v[20:23], v[48:51], v[220:223]
    ds_read_b128 v[64:67], v19 offset:18432
    v_mfma_f32_16x16x32_bf16 v[236:239], v[24:27], v[48:51], v[236:239]
    ds_read_b64_tr_b16 v[20:21], v9 offset:49152
    v_mfma_f32_16x16x32_bf16 v[232:235], v[24:27], v[44:47], v[232:235]
    ds_read_b64_tr_b16 v[22:23], v9 offset:51200
    v_mfma_f32_16x16x32_bf16 v[228:231], v[24:27], v[40:43], v[228:231]
    v_mfma_f32_16x16x32_bf16 v[224:227], v[24:27], v[36:39], v[224:227]
    s_waitcnt lgkmcnt(5)
    v_mfma_f32_16x16x32_bf16 v[128:131], v[28:31], v[52:55], v[128:131]
    ds_read_b64_tr_b16 v[24:25], v10 offset:49152
    s_waitcnt lgkmcnt(5)
    v_mfma_f32_16x16x32_bf16 v[132:135], v[28:31], v[56:59], v[132:135]
    ds_read_b64_tr_b16 v[26:27], v10 offset:51200
    s_waitcnt lgkmcnt(5)
    v_mfma_f32_16x16x32_bf16 v[136:139], v[28:31], v[60:63], v[136:139]
    s_waitcnt lgkmcnt(4)
    v_mfma_f32_16x16x32_bf16 v[140:143], v[28:31], v[64:67], v[140:143]
    s_waitcnt lgkmcnt(2)
    v_mfma_f32_16x16x32_bf16 v[252:255], v[20:23], v[64:67], v[252:255]
    ds_read_b64_tr_b16 v[28:29], v11 offset:49152
    v_mfma_f32_16x16x32_bf16 v[248:251], v[20:23], v[60:63], v[248:251]
    ds_read_b64_tr_b16 v[30:31], v11 offset:51200
    v_mfma_f32_16x16x32_bf16 v[244:247], v[20:23], v[56:59], v[244:247]
    v_mfma_f32_16x16x32_bf16 v[240:243], v[20:23], v[52:55], v[240:243]
    s_waitcnt lgkmcnt(2)
    v_mfma_f32_16x16x32_bf16 v[144:147], v[24:27], v[52:55], v[144:147]
    ds_read_b64_tr_b16 v[20:21], v12 offset:49152
    v_mfma_f32_16x16x32_bf16 v[148:151], v[24:27], v[56:59], v[148:151]
    ds_read_b64_tr_b16 v[22:23], v12 offset:51200
    v_mfma_f32_16x16x32_bf16 v[152:155], v[24:27], v[60:63], v[152:155]
    v_mfma_f32_16x16x32_bf16 v[156:159], v[24:27], v[64:67], v[156:159]
    s_waitcnt lgkmcnt(2)
    v_mfma_f32_16x16x32_bf16 v[172:175], v[28:31], v[64:67], v[172:175]
    ds_read_b64_tr_b16 v[24:25], v13 offset:49152
    v_mfma_f32_16x16x32_bf16 v[168:171], v[28:31], v[60:63], v[168:171]
    ds_read_b64_tr_b16 v[26:27], v13 offset:51200
    v_mfma_f32_16x16x32_bf16 v[164:167], v[28:31], v[56:59], v[164:167]
    v_mfma_f32_16x16x32_bf16 v[160:163], v[28:31], v[52:55], v[160:163]
    s_waitcnt lgkmcnt(2)
    v_mfma_f32_16x16x32_bf16 v[176:179], v[20:23], v[52:55], v[176:179]
    ds_read_b64_tr_b16 v[28:29], v14 offset:49152
    v_mfma_f32_16x16x32_bf16 v[180:183], v[20:23], v[56:59], v[180:183]
    ds_read_b64_tr_b16 v[30:31], v14 offset:51200
    v_mfma_f32_16x16x32_bf16 v[184:187], v[20:23], v[60:63], v[184:187]
    v_mfma_f32_16x16x32_bf16 v[188:191], v[20:23], v[64:67], v[188:191]
    s_waitcnt lgkmcnt(2)
    v_mfma_f32_16x16x32_bf16 v[204:207], v[24:27], v[64:67], v[204:207]
    ds_read_b64_tr_b16 v[20:21], v15 offset:49152
    v_mfma_f32_16x16x32_bf16 v[200:203], v[24:27], v[60:63], v[200:203]
    ds_read_b64_tr_b16 v[22:23], v15 offset:51200
    v_mfma_f32_16x16x32_bf16 v[196:199], v[24:27], v[56:59], v[196:199]
    v_mfma_f32_16x16x32_bf16 v[192:195], v[24:27], v[52:55], v[192:195]
    s_waitcnt lgkmcnt(0)
    s_barrier
    v_mfma_f32_16x16x32_bf16 v[208:211], v[28:31], v[52:55], v[208:211]
    ds_read_b64_tr_b16 v[24:25], v8 offset:0
    ds_read_b128 v[36:39], v16 offset:0
    v_mfma_f32_16x16x32_bf16 v[212:215], v[28:31], v[56:59], v[212:215]
    ds_read_b64_tr_b16 v[26:27], v8 offset:2048
    ds_read_b128 v[40:43], v16 offset:2048
    v_mfma_f32_16x16x32_bf16 v[216:219], v[28:31], v[60:63], v[216:219]
    ds_read_b128 v[44:47], v18 offset:0
    v_mfma_f32_16x16x32_bf16 v[220:223], v[28:31], v[64:67], v[220:223]
    ds_read_b128 v[48:51], v18 offset:2048
    v_mfma_f32_16x16x32_bf16 v[236:239], v[20:23], v[64:67], v[236:239]
    ds_read_b64_tr_b16 v[28:29], v9 offset:0
    v_mfma_f32_16x16x32_bf16 v[232:235], v[20:23], v[60:63], v[232:235]
    ds_read_b64_tr_b16 v[30:31], v9 offset:2048
    v_mfma_f32_16x16x32_bf16 v[228:231], v[20:23], v[56:59], v[228:231]
    v_mfma_f32_16x16x32_bf16 v[224:227], v[20:23], v[52:55], v[224:227]
    s_waitcnt lgkmcnt(5)
    v_mfma_f32_16x16x32_bf16 v[128:131], v[24:27], v[36:39], v[128:131]
    ds_read_b64_tr_b16 v[20:21], v10 offset:0
    s_waitcnt lgkmcnt(5)
    v_mfma_f32_16x16x32_bf16 v[132:135], v[24:27], v[40:43], v[132:135]
    ds_read_b64_tr_b16 v[22:23], v10 offset:2048
    s_waitcnt lgkmcnt(5)
    v_mfma_f32_16x16x32_bf16 v[136:139], v[24:27], v[44:47], v[136:139]
    s_waitcnt lgkmcnt(4)
    v_mfma_f32_16x16x32_bf16 v[140:143], v[24:27], v[48:51], v[140:143]
    s_waitcnt lgkmcnt(2)
    v_mfma_f32_16x16x32_bf16 v[252:255], v[28:31], v[48:51], v[252:255]
    ds_read_b64_tr_b16 v[24:25], v11 offset:0
    v_mfma_f32_16x16x32_bf16 v[248:251], v[28:31], v[44:47], v[248:251]
    ds_read_b64_tr_b16 v[26:27], v11 offset:2048
    v_mfma_f32_16x16x32_bf16 v[244:247], v[28:31], v[40:43], v[244:247]
    v_mfma_f32_16x16x32_bf16 v[240:243], v[28:31], v[36:39], v[240:243]
    s_waitcnt lgkmcnt(2)
    v_mfma_f32_16x16x32_bf16 v[144:147], v[20:23], v[36:39], v[144:147]
    ds_read_b64_tr_b16 v[28:29], v12 offset:0
    v_mfma_f32_16x16x32_bf16 v[148:151], v[20:23], v[40:43], v[148:151]
    ds_read_b64_tr_b16 v[30:31], v12 offset:2048
    v_mfma_f32_16x16x32_bf16 v[152:155], v[20:23], v[44:47], v[152:155]
    v_mfma_f32_16x16x32_bf16 v[156:159], v[20:23], v[48:51], v[156:159]
    s_waitcnt lgkmcnt(2)
    v_mfma_f32_16x16x32_bf16 v[172:175], v[24:27], v[48:51], v[172:175]
    ds_read_b64_tr_b16 v[20:21], v13 offset:0
    v_mfma_f32_16x16x32_bf16 v[168:171], v[24:27], v[44:47], v[168:171]
    ds_read_b64_tr_b16 v[22:23], v13 offset:2048
    v_mfma_f32_16x16x32_bf16 v[164:167], v[24:27], v[40:43], v[164:167]
    v_mfma_f32_16x16x32_bf16 v[160:163], v[24:27], v[36:39], v[160:163]
    s_waitcnt lgkmcnt(2)
    v_mfma_f32_16x16x32_bf16 v[176:179], v[28:31], v[36:39], v[176:179]
    ds_read_b64_tr_b16 v[24:25], v14 offset:0
    v_mfma_f32_16x16x32_bf16 v[180:183], v[28:31], v[40:43], v[180:183]
    ds_read_b64_tr_b16 v[26:27], v14 offset:2048
    v_mfma_f32_16x16x32_bf16 v[184:187], v[28:31], v[44:47], v[184:187]
    v_mfma_f32_16x16x32_bf16 v[188:191], v[28:31], v[48:51], v[188:191]
    s_waitcnt lgkmcnt(2)
    v_mfma_f32_16x16x32_bf16 v[204:207], v[20:23], v[48:51], v[204:207]
    ds_read_b64_tr_b16 v[28:29], v15 offset:0
    v_mfma_f32_16x16x32_bf16 v[200:203], v[20:23], v[44:47], v[200:203]
    ds_read_b64_tr_b16 v[30:31], v15 offset:2048
    v_mfma_f32_16x16x32_bf16 v[196:199], v[20:23], v[40:43], v[196:199]
    v_mfma_f32_16x16x32_bf16 v[192:195], v[20:23], v[36:39], v[192:195]
    s_waitcnt lgkmcnt(0)
    s_barrier
    v_mfma_f32_16x16x32_bf16 v[208:211], v[24:27], v[36:39], v[208:211]
    ds_read_b64_tr_b16 v[20:21], v8 offset:16384
    ds_read_b128 v[52:55], v17 offset:0
    v_mfma_f32_16x16x32_bf16 v[212:215], v[24:27], v[40:43], v[212:215]
    ds_read_b64_tr_b16 v[22:23], v8 offset:18432
    ds_read_b128 v[56:59], v17 offset:2048
    v_mfma_f32_16x16x32_bf16 v[216:219], v[24:27], v[44:47], v[216:219]
    ds_read_b128 v[60:63], v19 offset:0
    v_mfma_f32_16x16x32_bf16 v[220:223], v[24:27], v[48:51], v[220:223]
    ds_read_b128 v[64:67], v19 offset:2048
L_pg2:
    s_cbranch_execz L_pgback
    v_mfma_f32_16x16x32_bf16 v[236:239], v[28:31], v[48:51], v[236:239]
    ds_read_b64_tr_b16 v[24:25], v9 offset:16384
    v_mfma_f32_16x16x32_bf16 v[232:235], v[28:31], v[44:47], v[232:235]
    ds_read_b64_tr_b16 v[26:27], v9 offset:18432
    v_mfma_f32_16x16x32_bf16 v[228:231], v[28:31], v[40:43], v[228:231]
    v_mfma_f32_16x16x32_bf16 v[224:227], v[28:31], v[36:39], v[224:227]
    s_waitcnt lgkmcnt(5)
    v_mfma_f32_16x16x32_bf16 v[128:131], v[20:23], v[52:55], v[128:131]
    ds_read_b64_tr_b16 v[28:29], v10 offset:16384
    s_waitcnt lgkmcnt(5)
    v_mfma_f32_16x16x32_bf16 v[132:135], v[20:23], v[56:59], v[132:135]
    ds_read_b64_tr_b16 v[30:31], v10 offset:18432
    s_waitcnt lgkmcnt(5)
    v_mfma_f32_16x16x32_bf16 v[136:139], v[20:23], v[60:63], v[136:139]
    s_waitcnt lgkmcnt(4)
    v_mfma_f32_16x16x32_bf16 v[140:143], v[20:23], v[64:67], v[140:143]
    s_waitcnt lgkmcnt(2)
    v_mfma_f32_16x16x32_bf16 v[252:255], v[24:27], v[64:67], v[252:255]
    ds_read_b64_tr_b16 v[20:21], v11 offset:16384
    v_mfma_f32_16x16x32_bf16 v[248:251], v[24:27], v[60:63], v[248:251]
    ds_read_b64_tr_b16 v[22:23], v11 offset:18432
    v_mfma_f32_16x16x32_bf16 v[244:247], v[24:27], v[56:59], v[244:247]
    v_mfma_f32_16x16x32_bf16 v[240:243], v[24:27], v[52:55], v[240:243]
    s_waitcnt lgkmcnt(2)
    v_mfma_f32_16x16x32_bf16 v[144:147], v[28:31], v[52:55], v[144:147]
    ds_read_b64_tr_b16 v[24:25], v12 offset:16384
    v_mfma_f32_16x16x32_bf16 v[148:151], v[28:31], v[56:59], v[148:151]
    ds_read_b64_tr_b16 v[26:27], v12 offset:18432
    v_mfma_f32_16x16x32_bf16 v[152:155], v[28:31], v[60:63], v[152:155]
    v_mfma_f32_16x16x32_bf16 v[156:159], v[28:31], v[64:67], v[156:159]
    s_waitcnt lgkmcnt(2)
    v_mfma_f32_16x16x32_bf16 v[172:175], v[20:23], v[64:67], v[172:175]
    ds_read_b64_tr_b16 v[28:29], v13 offset:16384
    v_mfma_f32_16x16x32_bf16 v[168:171], v[20:23], v[60:63], v[168:171]
    ds_read_b64_tr_b16 v[30:31], v13 offset:18432
    v_mfma_f32_16x16x32_bf16 v[164:167], v[20:23], v[56:59], v[164:167]
    v_mfma_f32_16x16x32_bf16 v[160:163], v[20:23], v[52:55], v[160:163]
    s_waitcnt lgkmcnt(2)
    v_mfma_f32_16x16x32_bf16 v[176:179], v[24:27], v[52:55], v[176:179]
    ds_read_b64_tr_b16 v[20:21], v14 offset:16384
    v_mfma_f32_16x16x32_bf16 v[180:183], v[24:27], v[56:59], v[180:183]
    ds_read_b64_tr_b16 v[22:23], v14 offset:18432
    v_mfma_f32_16x16x32_bf16 v[184:187], v[24:27], v[60:63], v[184:187]
    v_mfma_f32_16x16x32_bf16 v[188:191], v[24:27], v[64:67], v[188:191]
    s_waitcnt lgkmcnt(2)
    v_mfma_f32_16x16x32_bf16 v[204:207], v[28:31], v[64:67], v[204:207]
    ds_read_b64_tr_b16 v[24:25], v15 offset:16384
    v_mfma_f32_16x16x32_bf16 v[200:203], v[28:31], v[60:63], v[200:203]
    ds_read_b64_tr_b16 v[26:27], v15 offset:18432
    v_mfma_f32_16x16x32_bf16 v[196:199], v[28:31], v[56:59], v[196:199]
    v_mfma_f32_16x16x32_bf16 v[192:195], v[28:31], v[52:55], v[192:195]
    s_waitcnt lgkmcnt(0)
    s_barrier
    v_mfma_f32_16x16x32_bf16 v[208:211], v[20:23], v[52:55], v[208:211]
    ds_read_b64_tr_b16 v[28:29], v8 offset:32768
    ds_read_b128 v[36:39], v16 offset:16384
    v_mfma_f32_16x16x32_bf16 v[212:215], v[20:23], v[56:59], v[212:215]
    ds_read_b64_tr_b16 v[30:31], v8 offset:34816
    ds_read_b128 v[40:43], v16 offset:18432
    v_mfma_f32_16x16x32_bf16 v[216:219], v[20:23], v[60:63], v[216:219]
    ds_read_b128 v[44:47], v18 offset:16384
    v_mfma_f32_16x16x32_bf16 v[220:223], v[20:23], v[64:67], v[220:223]
    ds_read_b128 v[48:51], v18 offset:18432
    v_mfma_f32_16x16x32_bf16 v[236:239], v[24:27], v[64:67], v[236:239]
    ds_read_b64_tr_b16 v[20:21], v9 offset:32768
    v_mfma_f32_16x16x32_bf16 v[232:235], v[24:27], v[60:63], v[232:235]
    ds_read_b64_tr_b16 v[22:23], v9 offset:34816
    v_mfma_f32_16x16x32_bf16 v[228:231], v[24:27], v[56:59], v[228:231]
    v_mfma_f32_16x16x32_bf16 v[224:227], v[24:27], v[52:55], v[224:227]
    s_waitcnt lgkmcnt(5)
    v_mfma_f32_16x16x32_bf16 v[128:131], v[28:31], v[36:39], v[128:131]
    ds_read_b64_tr_b16 v[24:25], v10 offset:32768
    s_waitcnt lgkmcnt(5)
    v_mfma_f32_16x16x32_bf16 v[132:135], v[28:31], v[40:43], v[132:135]
    ds_read_b64_tr_b16 v[26:27], v10 offset:34816
    s_waitcnt lgkmcnt(5)
    v_mfma_f32_16x16x32_bf16 v[136:139], v[28:31], v[44:47], v[136:139]
    s_waitcnt lgkmcnt(4)
    v_mfma_f32_16x16x32_bf16 v[140:143], v[28:31], v[48:51], v[140:143]
    s_waitcnt lgkmcnt(2)
    v_mfma_f32_16x16x32_bf16 v[252:255], v[20:23], v[48:51], v[252:255]
    ds_read_b64_tr_b16 v[28:29], v11 offset:32768
    v_mfma_f32_16x16x32_bf16 v[248:251], v[20:23], v[44:47], v[248:251]
    ds_read_b64_tr_b16 v[30:31], v11 offset:34816
    v_mfma_f32_16x16x32_bf16 v[244:247], v[20:23], v[40:43], v[244:247]
    v_mfma_f32_16x16x32_bf16 v[240:243], v[20:23], v[36:39], v[240:243]
    s_waitcnt lgkmcnt(2)
    v_mfma_f32_16x16x32_bf16 v[144:147], v[24:27], v[36:39], v[144:147]
    ds_read_b64_tr_b16 v[20:21], v12 offset:32768
    v_mfma_f32_16x16x32_bf16 v[148:151], v[24:27], v[40:43], v[148:151]
    ds_read_b64_tr_b16 v[22:23], v12 offset:34816
    v_mfma_f32_16x16x32_bf16 v[152:155], v[24:27], v[44:47], v[152:155]
    v_mfma_f32_16x16x32_bf16 v[156:159], v[24:27], v[48:51], v[156:159]
    s_waitcnt lgkmcnt(2)
    v_mfma_f32_16x16x32_bf16 v[172:175], v[28:31], v[48:51], v[172:175]
    ds_read_b64_tr_b16 v[24:25], v13 offset:32768
    v_mfma_f32_16x16x32_bf16 v[168:171], v[28:31], v[44:47], v[168:171]
    ds_read_b64_tr_b16 v[26:27], v13 offset:34816
    v_mfma_f32_16x16x32_bf16 v[164:167], v[28:31], v[40:43], v[164:167]
    v_mfma_f32_16x16x32_bf16 v[160:163], v[28:31], v[36:39], v[160:163]
    s_waitcnt lgkmcnt(2)
    v_mfma_f32_16x16x32_bf16 v[176:179], v[20:23], v[36:39], v[176:179]
    ds_read_b64_tr_b16 v[28:29], v14 offset:32768
    v_mfma_f32_16x16x32_bf16 v[180:183], v[20:23], v[40:43], v[180:183]
    ds_read_b64_tr_b16 v[30:31], v14 offset:34816
    v_mfma_f32_16x16x32_bf16 v[184:187], v[20:23], v[44:47], v[184:187]
    v_mfma_f32_16x16x32_bf16 v[188:191], v[20:23], v[48:51], v[188:191]
    s_waitcnt lgkmcnt(2)
    v_mfma_f32_16x16x32_bf16 v[204:207], v[24:27], v[48:51], v[204:207]
    ds_read_b64_tr_b16 v[20:21], v15 offset:32768
    v_mfma_f32_16x16x32_bf16 v[200:203], v[24:27], v[44:47], v[200:203]
    ds_read_b64_tr_b16 v[22:23], v15 offset:34816
    v_mfma_f32_16x16x32_bf16 v[196:199], v[24:27], v[40:43], v[196:199]
    v_mfma_f32_16x16x32_bf16 v[192:195], v[24:27], v[36:39], v[192:195]
    s_waitcnt lgkmcnt(0)
    s_barrier
    v_mfma_f32_16x16x32_bf16 v[208:211], v[28:31], v[36:39], v[208:211]
    ds_read_b64_tr_b16 v[24:25], v8 offset:49152
    ds_read_b128 v[52:55], v17 offset:16384
    v_mfma_f32_16x16x32_bf16 v[212:215], v[28:31], v[40:43], v[212:215]
    ds_read_b64_tr_b16 v[26:27], v8 offset:51200
    ds_read_b128 v[56:59], v17 offset:18432
    v_mfma_f32_16x16x32_bf16 v[216:219], v[28:31], v[44:47], v[216:219]
    ds_read_b128 v[60:63], v19 offset:16384
    v_mfma_f32_16x16x32_bf16 v[220:223], v[28:31], v[48:51], v[220:223]
    ds_read_b128 v[64:67], v19 offset:18432
    v_mfma_f32_16x16x32_bf16 v[236:239], v[20:23], v[48:51], v[236:239]
    ds_read_b64_tr_b16 v[28:29], v9 offset:49152
    v_mfma_f32_16x16x32_bf16 v[232:235], v[20:23], v[44:47], v[232:235]
    ds_read_b64_tr_b16 v[30:31], v9 offset:51200
    v_mfma_f32_16x16x32_bf16 v[228:231], v[20:23], v[40:43], v[228:231]
    v_mfma_f32_16x16x32_bf16 v[224:227], v[20:23], v[36:39], v[224:227]
    s_waitcnt lgkmcnt(5)
    v_mfma_f32_16x16x32_bf16 v[128:131], v[24:27], v[52:55], v[128:131]
    ds_read_b64_tr_b16 v[20:21], v10 offset:49152
    s_waitcnt lgkmcnt(5)
    v_mfma_f32_16x16x32_bf16 v[132:135], v[24:27], v[56:59], v[132:135]
    ds_read_b64_tr_b16 v[22:23], v10 offset:51200
    s_waitcnt lgkmcnt(5)
    v_mfma_f32_16x16x32_bf16 v[136:139], v[24:27], v[60:63], v[136:139]
    s_waitcnt lgkmcnt(4)
    v_mfma_f32_16x16x32_bf16 v[140:143], v[24:27], v[64:67], v[140:143]
    s_waitcnt lgkmcnt(2)
    v_mfma_f32_16x16x32_bf16 v[252:255], v[28:31], v[64:67], v[252:255]
    ds_read_b64_tr_b16 v[24:25], v11 offset:49152
    v_mfma_f32_16x16x32_bf16 v[248:251], v[28:31], v[60:63], v[248:251]
    ds_read_b64_tr_b16 v[26:27], v11 offset:51200
    v_mfma_f32_16x16x32_bf16 v[244:247], v[28:31], v[56:59], v[244:247]
    v_mfma_f32_16x16x32_bf16 v[240:243], v[28:31], v[52:55], v[240:243]
    s_waitcnt lgkmcnt(2)
    v_mfma_f32_16x16x32_bf16 v[144:147], v[20:23], v[52:55], v[144:147]
    ds_read_b64_tr_b16 v[28:29], v12 offset:49152
    v_mfma_f32_16x16x32_bf16 v[148:151], v[20:23], v[56:59], v[148:151]
    ds_read_b64_tr_b16 v[30:31], v12 offset:51200
    v_mfma_f32_16x16x32_bf16 v[152:155], v[20:23], v[60:63], v[152:155]
    v_mfma_f32_16x16x32_bf16 v[156:159], v[20:23], v[64:67], v[156:159]
    s_waitcnt lgkmcnt(2)
    v_mfma_f32_16x16x32_bf16 v[172:175], v[24:27], v[64:67], v[172:175]
    ds_read_b64_tr_b16 v[20:21], v13 offset:49152
    v_mfma_f32_16x16x32_bf16 v[168:171], v[24:27], v[60:63], v[168:171]
    ds_read_b64_tr_b16 v[22:23], v13 offset:51200
    v_mfma_f32_16x16x32_bf16 v[164:167], v[24:27], v[56:59], v[164:167]
    v_mfma_f32_16x16x32_bf16 v[160:163], v[24:27], v[52:55], v[160:163]
    s_waitcnt lgkmcnt(2)
    v_mfma_f32_16x16x32_bf16 v[176:179], v[28:31], v[52:55], v[176:179]
    ds_read_b64_tr_b16 v[24:25], v14 offset:49152
    v_mfma_f32_16x16x32_bf16 v[180:183], v[28:31], v[56:59], v[180:183]
    ds_read_b64_tr_b16 v[26:27], v14 offset:51200
    v_mfma_f32_16x16x32_bf16 v[184:187], v[28:31], v[60:63], v[184:187]
    v_mfma_f32_16x16x32_bf16 v[188:191], v[28:31], v[64:67], v[188:191]
    s_waitcnt lgkmcnt(2)
    v_mfma_f32_16x16x32_bf16 v[204:207], v[20:23], v[64:67], v[204:207]
    ds_read_b64_tr_b16 v[28:29], v15 offset:49152
    v_mfma_f32_16x16x32_bf16 v[200:203], v[20:23], v[60:63], v[200:203]
    ds_read_b64_tr_b16 v[30:31], v15 offset:51200
    v_mfma_f32_16x16x32_bf16 v[196:199], v[20:23], v[56:59], v[196:199]
    v_mfma_f32_16x16x32_bf16 v[192:195], v[20:23], v[52:55], v[192:195]
    s_waitcnt lgkmcnt(0)
    s_barrier
    v_mfma_f32_16x16x32_bf16 v[208:211], v[24:27], v[52:55], v[208:211]
    ds_read_b64_tr_b16 v[20:21], v8 offset:0
    ds_read_b128 v[36:39], v16 offset:0
    v_mfma_f32_16x16x32_bf16 v[212:215], v[24:27], v[56:59], v[212:215]
    ds_read_b64_tr_b16 v[22:23], v8 offset:2048
    ds_read_b128 v[40:43], v16 offset:2048
    v_mfma_f32_16x16x32_bf16 v[216:219], v[24:27], v[60:63], v[216:219]
    ds_read_b128 v[44:47], v18 offset:0
    v_xor_b32 v0, 0, v1
    v_mfma_f32_16x16x32_bf16 v[220:223], v[24:27], v[64:67], v[220:223]
    ds_read_b128 v[48:51], v18 offset:2048
    ds_read_b64 v[76:77], v0 offset:16384
    v_mfma_f32_16x16x32_bf16 v[236:239], v[28:31], v[64:67], v[236:239]
    ds_read_b64_tr_b16 v[24:25], v9 offset:0
    ds_read_b64 v[80:81], v0 offset:24576
    v_mfma_f32_16x16x32_bf16 v[232:235], v[28:31], v[60:63], v[232:235]
    ds_read_b64_tr_b16 v[26:27], v9 offset:2048
    ds_read_b64 v[68:69], v0 offset:0
    v_mfma_f32_16x16x32_bf16 v[228:231], v[28:31], v[56:59], v[228:231]
    ds_read_b64 v[72:73], v0 offset:8192
    v_xor_b32 v0, 32, v1
    v_mfma_f32_16x16x32_bf16 v[224:227], v[28:31], v[52:55], v[224:227]
    ds_read_b64 v[78:79], v0 offset:16384
    s_waitcnt lgkmcnt(10)
    v_mfma_f32_16x16x32_bf16 v[128:131], v[20:23], v[36:39], v[128:131]
    ds_read_b64_tr_b16 v[28:29], v10 offset:0
    s_waitcnt lgkmcnt(10)
    v_mfma_f32_16x16x32_bf16 v[132:135], v[20:23], v[40:43], v[132:135]
    ds_read_b64_tr_b16 v[30:31], v10 offset:2048
    s_waitcnt lgkmcnt(10)
    v_mfma_f32_16x16x32_bf16 v[136:139], v[20:23], v[44:47], v[136:139]
    ds_read_b64 v[82:83], v0 offset:24576
    s_waitcnt lgkmcnt(9)
    v_mfma_f32_16x16x32_bf16 v[140:143], v[20:23], v[48:51], v[140:143]
    ds_read_b64 v[70:71], v0 offset:0
    s_waitcnt lgkmcnt(7)
    v_mfma_f32_16x16x32_bf16 v[252:255], v[24:27], v[48:51], v[252:255]
    ds_read_b64_tr_b16 v[20:21], v11 offset:0
    ds_read_b64 v[74:75], v0 offset:8192
    v_mfma_f32_16x16x32_bf16 v[248:251], v[24:27], v[44:47], v[248:251]
    ds_read_b64_tr_b16 v[22:23], v11 offset:2048
    v_xor_b32 v0, 64, v1
    v_mfma_f32_16x16x32_bf16 v[244:247], v[24:27], v[40:43], v[244:247]
    ds_read_b64 v[92:93], v0 offset:16384
    ds_read_b64 v[96:97], v0 offset:24576
    v_mfma_f32_16x16x32_bf16 v[240:243], v[24:27], v[36:39], v[240:243]
    ds_read_b64 v[84:85], v0 offset:0
    s_waitcnt lgkmcnt(8)
    v_mfma_f32_16x16x32_bf16 v[144:147], v[28:31], v[36:39], v[144:147]
    ds_read_b64_tr_b16 v[24:25], v12 offset:0
    ds_read_b64 v[88:89], v0 offset:8192
    v_mfma_f32_16x16x32_bf16 v[148:151], v[28:31], v[40:43], v[148:151]
    ds_read_b64_tr_b16 v[26:27], v12 offset:2048
    v_xor_b32 v0, 96, v1
    v_mfma_f32_16x16x32_bf16 v[152:155], v[28:31], v[44:47], v[152:155]
    ds_read_b64 v[94:95], v0 offset:16384
    ds_read_b64 v[98:99], v0 offset:24576
    v_mfma_f32_16x16x32_bf16 v[156:159], v[28:31], v[48:51], v[156:159]
    ds_read_b64 v[86:87], v0 offset:0
    s_waitcnt lgkmcnt(9)
    v_mfma_f32_16x16x32_bf16 v[172:175], v[20:23], v[48:51], v[172:175]
    ds_read_b64_tr_b16 v[28:29], v13 offset:0
    ds_read_b64 v[90:91], v0 offset:8192
    v_mfma_f32_16x16x32_bf16 v[168:171], v[20:23], v[44:47], v[168:171]
    ds_read_b64_tr_b16 v[30:31], v13 offset:2048
    v_xor_b32 v0, 128, v1
    v_mfma_f32_16x16x32_bf16 v[164:167], v[20:23], v[40:43], v[164:167]
    ds_read_b64 v[108:109], v0 offset:16384
    ds_read_b64 v[112:113], v0 offset:24576
    v_mfma_f32_16x16x32_bf16 v[160:163], v[20:23], v[36:39], v[160:163]
    ds_read_b64 v[100:101], v0 offset:0
    s_waitcnt lgkmcnt(9)
    v_mfma_f32_16x16x32_bf16 v[176:179], v[24:27], v[36:39], v[176:179]
    ds_read_b64_tr_b16 v[20:21], v14 offset:0
    ds_read_b64 v[104:105], v0 offset:8192
    v_mfma_f32_16x16x32_bf16 v[180:183], v[24:27], v[40:43], v[180:183]
    ds_read_b64_tr_b16 v[22:23], v14 offset:2048
    v_xor_b32 v0, 160, v1
    v_mfma_f32_16x16x32_bf16 v[184:187], v[24:27], v[44:47], v[184:187]
    ds_read_b64 v[110:111], v0 offset:16384
    ds_read_b64 v[114:115], v0 offset:24576
    v_mfma_f32_16x16x32_bf16 v[188:191], v[24:27], v[48:51], v[188:191]
    ds_read_b64 v[102:103], v0 offset:0
    s_waitcnt lgkmcnt(9)
    v_mfma_f32_16x16x32_bf16 v[204:207], v[28:31], v[48:51], v[204:207]
    ds_read_b64_tr_b16 v[24:25], v15 offset:0
    ds_read_b64 v[106:107], v0 offset:8192
    v_mfma_f32_16x16x32_bf16 v[200:203], v[28:31], v[44:47], v[200:203]
    ds_read_b64_tr_b16 v[26:27], v15 offset:2048
    v_xor_b32 v0, 192, v1
    v_mfma_f32_16x16x32_bf16 v[196:199], v[28:31], v[40:43], v[196:199]
    ds_read_b64 v[124:125], v0 offset:16384
    ds_read_b64 v[4:5], v0 offset:24576
    v_mfma_f32_16x16x32_bf16 v[192:195], v[28:31], v[36:39], v[192:195]
    s_waitcnt lgkmcnt(0)
    s_barrier
    v_mfma_f32_16x16x32_bf16 v[208:211], v[20:23], v[36:39], v[208:211]
    ds_read_b64_tr_b16 v[28:29], v8 offset:16384
    ds_read_b128 v[52:55], v17 offset:0
    v_mfma_f32_16x16x32_bf16 v[212:215], v[20:23], v[40:43], v[212:215]
    ds_read_b64_tr_b16 v[30:31], v8 offset:18432
    ds_read_b128 v[56:59], v17 offset:2048
    v_mfma_f32_16x16x32_bf16 v[216:219], v[20:23], v[44:47], v[216:219]
    ds_read_b128 v[60:63], v19 offset:0
    ds_read_b64 v[116:117], v0 offset:0
    v_mfma_f32_16x16x32_bf16 v[220:223], v[20:23], v[48:51], v[220:223]
    ds_read_b128 v[64:67], v19 offset:2048
    ds_read_b64 v[120:121], v0 offset:8192
    v_mfma_f32_16x16x32_bf16 v[236:239], v[24:27], v[48:51], v[236:239]
    ds_read_b64_tr_b16 v[20:21], v9 offset:16384
    v_xor_b32 v0, 224, v1
    v_mfma_f32_16x16x32_bf16 v[232:235], v[24:27], v[44:47], v[232:235]
    ds_read_b64_tr_b16 v[22:23], v9 offset:18432
    ds_read_b64 v[126:127], v0 offset:16384
    v_mfma_f32_16x16x32_bf16 v[228:231], v[24:27], v[40:43], v[228:231]
    ds_read_b64 v[6:7], v0 offset:24576
    ds_read_b64 v[118:119], v0 offset:0
    v_mfma_f32_16x16x32_bf16 v[224:227], v[24:27], v[36:39], v[224:227]
    ds_read_b64 v[122:123], v0 offset:8192
    s_waitcnt lgkmcnt(11)
    v_mfma_f32_16x16x32_bf16 v[128:131], v[28:31], v[52:55], v[128:131]
    ds_read_b64_tr_b16 v[24:25], v10 offset:16384
    s_waitcnt lgkmcnt(11)
    v_mfma_f32_16x16x32_bf16 v[132:135], v[28:31], v[56:59], v[132:135]
    ds_read_b64_tr_b16 v[26:27], v10 offset:18432
    s_waitcnt lgkmcnt(10)
    v_mfma_f32_16x16x32_bf16 v[136:139], v[28:31], v[60:63], v[136:139]
    s_waitcnt lgkmcnt(8)
    v_mfma_f32_16x16x32_bf16 v[140:143], v[28:31], v[64:67], v[140:143]
    s_waitcnt lgkmcnt(6)
    v_mfma_f32_16x16x32_bf16 v[252:255], v[20:23], v[64:67], v[252:255]
    ds_read_b64_tr_b16 v[28:29], v11 offset:16384
    v_mfma_f32_16x16x32_bf16 v[248:251], v[20:23], v[60:63], v[248:251]
    ds_read_b64_tr_b16 v[30:31], v11 offset:18432
    v_mfma_f32_16x16x32_bf16 v[244:247], v[20:23], v[56:59], v[244:247]
    v_mfma_f32_16x16x32_bf16 v[240:243], v[20:23], v[52:55], v[240:243]
    s_waitcnt lgkmcnt(2)
    v_mfma_f32_16x16x32_bf16 v[144:147], v[24:27], v[52:55], v[144:147]
    ds_read_b64_tr_b16 v[20:21], v12 offset:16384
    v_mfma_f32_16x16x32_bf16 v[148:151], v[24:27], v[56:59], v[148:151]
    ds_read_b64_tr_b16 v[22:23], v12 offset:18432
    v_cvt_pk_bf16_f32 v136, v136, v137
    v_mfma_f32_16x16x32_bf16 v[152:155], v[24:27], v[60:63], v[152:155]
    v_cvt_pk_bf16_f32 v137, v138, v139
    v_cvt_pk_bf16_f32 v138, v248, v249
    v_mfma_f32_16x16x32_bf16 v[156:159], v[24:27], v[64:67], v[156:159]
    v_cvt_pk_bf16_f32 v139, v250, v251
    s_waitcnt lgkmcnt(2)
    v_mfma_f32_16x16x32_bf16 v[172:175], v[28:31], v[64:67], v[172:175]
    ds_read_b64_tr_b16 v[24:25], v13 offset:16384
    v_cvt_pk_bf16_f32 v140, v140, v141
    v_mfma_f32_16x16x32_bf16 v[168:171], v[28:31], v[60:63], v[168:171]
    ds_read_b64_tr_b16 v[26:27], v13 offset:18432
    v_cvt_pk_bf16_f32 v141, v142, v143
    v_mfma_f32_16x16x32_bf16 v[164:167], v[28:31], v[56:59], v[164:167]
    v_cvt_pk_bf16_f32 v142, v252, v253
    v_cvt_pk_bf16_f32 v143, v254, v255
    v_mfma_f32_16x16x32_bf16 v[160:163], v[28:31], v[52:55], v[160:163]
    v_cvt_pk_bf16_f32 v128, v128, v129
    s_waitcnt lgkmcnt(2)
    v_mfma_f32_16x16x32_bf16 v[176:179], v[20:23], v[52:55], v[176:179]
    ds_read_b64_tr_b16 v[28:29], v14 offset:16384
    v_cvt_pk_bf16_f32 v129, v130, v131
    v_mfma_f32_16x16x32_bf16 v[180:183], v[20:23], v[56:59], v[180:183]
    ds_read_b64_tr_b16 v[30:31], v14 offset:18432
    v_cvt_pk_bf16_f32 v152, v152, v153
    v_mfma_f32_16x16x32_bf16 v[184:187], v[20:23], v[60:63], v[184:187]
    v_cvt_pk_bf16_f32 v153, v154, v155
    v_cvt_pk_bf16_f32 v154, v168, v169
    v_mfma_f32_16x16x32_bf16 v[188:191], v[20:23], v[64:67], v[188:191]
    v_cvt_pk_bf16_f32 v155, v170, v171
    s_waitcnt lgkmcnt(2)
    v_mfma_f32_16x16x32_bf16 v[204:207], v[24:27], v[64:67], v[204:207]
    ds_read_b64_tr_b16 v[20:21], v15 offset:16384
    v_cvt_pk_bf16_f32 v156, v156, v157
    v_mfma_f32_16x16x32_bf16 v[200:203], v[24:27], v[60:63], v[200:203]
    ds_read_b64_tr_b16 v[22:23], v15 offset:18432
    v_cvt_pk_bf16_f32 v157, v158, v159
    v_mfma_f32_16x16x32_bf16 v[196:199], v[24:27], v[56:59], v[196:199]
    v_cvt_pk_bf16_f32 v158, v172, v173
    v_cvt_pk_bf16_f32 v159, v174, v175
    v_mfma_f32_16x16x32_bf16 v[192:195], v[24:27], v[52:55], v[192:195]
    s_waitcnt lgkmcnt(0)
    s_barrier
    v_mfma_f32_16x16x32_bf16 v[208:211], v[28:31], v[52:55], v[208:211]
    v_cvt_pk_bf16_f32 v144, v144, v145
    v_cvt_pk_bf16_f32 v145, v146, v147
    v_mfma_f32_16x16x32_bf16 v[212:215], v[28:31], v[56:59], v[212:215]
    v_cvt_pk_bf16_f32 v146, v160, v161
    v_cvt_pk_bf16_f32 v147, v162, v163
    v_mfma_f32_16x16x32_bf16 v[216:219], v[28:31], v[60:63], v[216:219]
    v_cvt_pk_bf16_f32 v148, v148, v149
    v_cvt_pk_bf16_f32 v149, v150, v151
    v_mfma_f32_16x16x32_bf16 v[220:223], v[28:31], v[64:67], v[220:223]
    v_cvt_pk_bf16_f32 v150, v164, v165
    v_cvt_pk_bf16_f32 v151, v166, v167
    v_mfma_f32_16x16x32_bf16 v[236:239], v[20:23], v[64:67], v[236:239]
    v_cvt_pk_bf16_f32 v130, v240, v241
    v_cvt_pk_bf16_f32 v131, v242, v243
    v_mfma_f32_16x16x32_bf16 v[232:235], v[20:23], v[60:63], v[232:235]
    v_cvt_pk_bf16_f32 v132, v132, v133
    v_cvt_pk_bf16_f32 v133, v134, v135
    v_mfma_f32_16x16x32_bf16 v[228:231], v[20:23], v[56:59], v[228:231]
    v_cvt_pk_bf16_f32 v134, v244, v245
    v_cvt_pk_bf16_f32 v135, v246, v247
    v_mfma_f32_16x16x32_bf16 v[224:227], v[20:23], v[52:55], v[224:227]
    v_cvt_pk_bf16_f32 v184, v184, v185
    v_cvt_pk_bf16_f32 v185, v186, v187
    v_mfma_f32_16x16x32_bf16 v[160:163], v[76:79], v[136:139], 0
    v_cvt_pk_bf16_f32 v186, v200, v201
    v_cvt_pk_bf16_f32 v187, v202, v203
    v_mfma_f32_16x16x32_bf16 v[164:167], v[76:79], v[140:143], 0
    v_cvt_pk_bf16_f32 v188, v188, v189
    v_cvt_pk_bf16_f32 v189, v190, v191
    v_mfma_f32_16x16x32_bf16 v[168:171], v[80:83], v[136:139], 0
    v_cvt_pk_bf16_f32 v190, v204, v205
    v_cvt_pk_bf16_f32 v191, v206, v207
    v_mfma_f32_16x16x32_bf16 v[172:175], v[80:83], v[140:143], 0
    v_cvt_pk_bf16_f32 v176, v176, v177
    v_cvt_pk_bf16_f32 v177, v178, v179
    v_mfma_f32_16x16x32_bf16 v[240:243], v[68:71], v[128:131], 0
    v_cvt_pk_bf16_f32 v178, v192, v193
    v_cvt_pk_bf16_f32 v179, v194, v195
    v_mfma_f32_16x16x32_bf16 v[244:247], v[68:71], v[132:135], 0
    v_cvt_pk_bf16_f32 v180, v180, v181
    v_cvt_pk_bf16_f32 v181, v182, v183
    v_mfma_f32_16x16x32_bf16 v[248:251], v[72:75], v[128:131], 0
    v_cvt_pk_bf16_f32 v182, v196, v197
    v_cvt_pk_bf16_f32 v183, v198, v199
    v_mfma_f32_16x16x32_bf16 v[252:255], v[72:75], v[132:135], 0
    v_add_u32 v0, s20, v2
    v_xor_b32 v1, 0x1000, v0
    v_mfma_f32_16x16x32_bf16 v[160:163], v[92:95], v[152:155], v[160:163]
    v_cvt_pk_bf16_f32 v216, v216, v217
    v_cvt_pk_bf16_f32 v217, v218, v219
    v_mfma_f32_16x16x32_bf16 v[164:167], v[92:95], v[156:159], v[164:167]
    v_cvt_pk_bf16_f32 v218, v232, v233
    v_cvt_pk_bf16_f32 v219, v234, v235
    v_mfma_f32_16x16x32_bf16 v[168:171], v[96:99], v[152:155], v[168:171]
    v_cvt_pk_bf16_f32 v220, v220, v221
    v_cvt_pk_bf16_f32 v221, v222, v223
    v_mfma_f32_16x16x32_bf16 v[172:175], v[96:99], v[156:159], v[172:175]
    v_cvt_pk_bf16_f32 v222, v236, v237
    v_cvt_pk_bf16_f32 v223, v238, v239
    v_mfma_f32_16x16x32_bf16 v[240:243], v[84:87], v[144:147], v[240:243]
    v_cvt_pk_bf16_f32 v208, v208, v209
    v_cvt_pk_bf16_f32 v209, v210, v211
    v_mfma_f32_16x16x32_bf16 v[244:247], v[84:87], v[148:151], v[244:247]
    v_cvt_pk_bf16_f32 v210, v224, v225
    v_cvt_pk_bf16_f32 v211, v226, v227
    v_mfma_f32_16x16x32_bf16 v[248:251], v[88:91], v[144:147], v[248:251]
    v_cvt_pk_bf16_f32 v212, v212, v213
    v_cvt_pk_bf16_f32 v213, v214, v215
    v_mfma_f32_16x16x32_bf16 v[252:255], v[88:91], v[148:151], v[252:255]
    v_cvt_pk_bf16_f32 v214, v228, v229
    v_cvt_pk_bf16_f32 v215, v230, v231
    v_mfma_f32_16x16x32_bf16 v[160:163], v[108:111], v[184:187], v[160:163]
    v_mfma_f32_16x16x32_bf16 v[164:167], v[108:111], v[188:191], v[164:167]
    v_mfma_f32_16x16x32_bf16 v[168:171], v[112:115], v[184:187], v[168:171]
    v_mfma_f32_16x16x32_bf16 v[172:175], v[112:115], v[188:191], v[172:175]
    v_xor_b32 v8, s44, v3
    v_mfma_f32_16x16x32_bf16 v[240:243], v[100:103], v[176:179], v[240:243]
    s_barrier
    v_mfma_f32_16x16x32_bf16 v[244:247], v[100:103], v[180:183], v[244:247]
    ds_read_b64_tr_b16 v[24:25], v8 offset:32768
    ds_read_b128 v[36:39], v16 offset:16384
    v_mfma_f32_16x16x32_bf16 v[248:251], v[104:107], v[176:179], v[248:251]
    ds_read_b64_tr_b16 v[26:27], v8 offset:34816
    ds_read_b128 v[40:43], v16 offset:18432
    v_mfma_f32_16x16x32_bf16 v[252:255], v[104:107], v[180:183], v[252:255]
    v_xor_b32 v9, s45, v3
    ds_read_b128 v[44:47], v18 offset:16384
    v_mfma_f32_16x16x32_bf16 v[160:163], v[124:127], v[216:219], v[160:163]
    ds_read_b128 v[48:51], v18 offset:18432
    v_mfma_f32_16x16x32_bf16 v[164:167], v[124:127], v[220:223], v[164:167]
    ds_read_b64_tr_b16 v[28:29], v9 offset:32768
    v_mfma_f32_16x16x32_bf16 v[168:171], v[4:7], v[216:219], v[168:171]
    ds_read_b64_tr_b16 v[30:31], v9 offset:34816
    v_mfma_f32_16x16x32_bf16 v[172:175], v[4:7], v[220:223], v[172:175]
    v_mfma_f32_16x16x32_bf16 v[240:243], v[116:119], v[208:211], v[240:243]
    v_mfma_f32_16x16x32_bf16 v[244:247], v[116:119], v[212:215], v[244:247]
    v_mfma_f32_16x16x32_bf16 v[248:251], v[120:123], v[208:211], v[248:251]
    ds_write_b128 v1, v[160:163] offset:0
    v_mfma_f32_16x16x32_bf16 v[252:255], v[120:123], v[212:215], v[252:255]
    s_waitcnt lgkmcnt(3)
    v_mfma_f32_16x16x32_bf16 v[128:131], v[36:39], v[24:27], 0
    v_xor_b32 v10, s46, v3
    ds_read_b64_tr_b16 v[20:21], v10 offset:32768
    v_mfma_f32_16x16x32_bf16 v[132:135], v[40:43], v[24:27], 0
    ds_read_b64_tr_b16 v[22:23], v10 offset:34816
    v_mfma_f32_16x16x32_bf16 v[136:139], v[44:47], v[24:27], 0
    ds_write_b128 v1, v[164:167] offset:1024
    v_mfma_f32_16x16x32_bf16 v[140:143], v[48:51], v[24:27], 0
    s_waitcnt lgkmcnt(4)
    v_mfma_f32_16x16x32_bf16 v[156:159], v[48:51], v[28:31], 0
    ds_write_b128 v1, v[168:171] offset:2048
    v_mfma_f32_16x16x32_bf16 v[152:155], v[44:47], v[28:31], 0
    ds_write_b128 v1, v[172:175] offset:3072
    v_mfma_f32_16x16x32_bf16 v[148:151], v[40:43], v[28:31], 0
    v_xor_b32 v11, s47, v3
    ds_read_b64_tr_b16 v[24:25], v11 offset:32768
    v_mfma_f32_16x16x32_bf16 v[144:147], v[36:39], v[28:31], 0
    ds_read_b64_tr_b16 v[26:27], v11 offset:34816
    s_waitcnt lgkmcnt(5)
    v_mfma_f32_16x16x32_bf16 v[160:163], v[36:39], v[20:23], 0
    v_xor_b32 v12, s48, v3
    ds_read_b64_tr_b16 v[28:29], v12 offset:32768
    v_mfma_f32_16x16x32_bf16 v[164:167], v[40:43], v[20:23], 0
    ds_read_b64_tr_b16 v[30:31], v12 offset:34816
    v_mfma_f32_16x16x32_bf16 v[168:171], v[44:47], v[20:23], 0
    ds_write_b128 v0, v[240:243] offset:0
    v_mfma_f32_16x16x32_bf16 v[172:175], v[48:51], v[20:23], 0
    s_waitcnt lgkmcnt(3)
    v_mfma_f32_16x16x32_bf16 v[188:191], v[48:51], v[24:27], 0
    ds_write_b128 v0, v[244:247] offset:1024
    ds_write_b128 v0, v[248:251] offset:2048
    ds_write_b128 v0, v[252:255] offset:3072
    v_mfma_f32_16x16x32_bf16 v[184:187], v[44:47], v[24:27], 0
    s_waitcnt lgkmcnt(0)
    s_barrier
    v_mfma_f32_16x16x32_bf16 v[180:183], v[40:43], v[24:27], 0
    v_xor_b32 v13, s49, v3
    ds_read_b64_tr_b16 v[20:21], v13 offset:32768
    v_mfma_f32_16x16x32_bf16 v[176:179], v[36:39], v[24:27], 0
    ds_read_b64_tr_b16 v[22:23], v13 offset:34816
    v_mfma_f32_16x16x32_bf16 v[192:195], v[36:39], v[28:31], 0
    v_xor_b32 v14, s50, v3
    ds_read_b64_tr_b16 v[24:25], v14 offset:32768
    v_mfma_f32_16x16x32_bf16 v[196:199], v[40:43], v[28:31], 0
    ds_read_b64_tr_b16 v[26:27], v14 offset:34816
    v_mfma_f32_16x16x32_bf16 v[200:203], v[44:47], v[28:31], 0
    v_mfma_f32_16x16x32_bf16 v[204:207], v[48:51], v[28:31], 0
    s_waitcnt lgkmcnt(0)
    s_barrier
    v_mfma_f32_16x16x32_bf16 v[220:223], v[48:51], v[20:23], 0
    ds_read_b64_tr_b16 v[28:29], v8 offset:49152
    ds_read_b128 v[52:55], v17 offset:16384
    v_mfma_f32_16x16x32_bf16 v[216:219], v[44:47], v[20:23], 0
    ds_read_b64_tr_b16 v[30:31], v8 offset:51200
    ds_read_b128 v[56:59], v17 offset:18432
    v_mfma_f32_16x16x32_bf16 v[212:215], v[40:43], v[20:23], 0
    ds_read_b128 v[60:63], v19 offset:16384
    v_mfma_f32_16x16x32_bf16 v[208:211], v[36:39], v[20:23], 0
    ds_read_b128 v[64:67], v19 offset:18432
    v_mfma_f32_16x16x32_bf16 v[224:227], v[36:39], v[24:27], 0
    ds_read_b64_tr_b16 v[20:21], v9 offset:49152
    v_mfma_f32_16x16x32_bf16 v[228:231], v[40:43], v[24:27], 0
    ds_read_b64_tr_b16 v[22:23], v9 offset:51200
    v_mfma_f32_16x16x32_bf16 v[232:235], v[44:47], v[24:27], 0
    v_mfma_f32_16x16x32_bf16 v[236:239], v[48:51], v[24:27], 0
    s_waitcnt lgkmcnt(5)
    v_mfma_f32_16x16x32_bf16 v[128:131], v[52:55], v[28:31], v[128:131]
    ds_read_b64_tr_b16 v[24:25], v10 offset:49152
    s_waitcnt lgkmcnt(5)
    v_mfma_f32_16x16x32_bf16 v[132:135], v[56:59], v[28:31], v[132:135]
    ds_read_b64_tr_b16 v[26:27], v10 offset:51200
    s_waitcnt lgkmcnt(5)
    v_mfma_f32_16x16x32_bf16 v[136:139], v[60:63], v[28:31], v[136:139]
    s_waitcnt lgkmcnt(4)
    v_mfma_f32_16x16x32_bf16 v[140:143], v[64:67], v[28:31], v[140:143]
    s_waitcnt lgkmcnt(2)
    v_mfma_f32_16x16x32_bf16 v[156:159], v[64:67], v[20:23], v[156:159]
    ds_read_b64_tr_b16 v[28:29], v11 offset:49152
    v_mfma_f32_16x16x32_bf16 v[152:155], v[60:63], v[20:23], v[152:155]
    ds_read_b64_tr_b16 v[30:31], v11 offset:51200
    v_mfma_f32_16x16x32_bf16 v[148:151], v[56:59], v[20:23], v[148:151]
    v_mfma_f32_16x16x32_bf16 v[144:147], v[52:55], v[20:23], v[144:147]
    s_waitcnt lgkmcnt(2)
    v_mfma_f32_16x16x32_bf16 v[160:163], v[52:55], v[24:27], v[160:163]
    ds_read_b64_tr_b16 v[20:21], v12 offset:49152
    v_mfma_f32_16x16x32_bf16 v[164:167], v[56:59], v[24:27], v[164:167]
    ds_read_b64_tr_b16 v[22:23], v12 offset:51200
    v_mfma_f32_16x16x32_bf16 v[168:171], v[60:63], v[24:27], v[168:171]
L_pg3:
    s_cbranch_execz L_pgback
    v_mfma_f32_16x16x32_bf16 v[172:175], v[64:67], v[24:27], v[172:175]
    s_waitcnt lgkmcnt(2)
    v_mfma_f32_16x16x32_bf16 v[188:191], v[64:67], v[28:31], v[188:191]
    ds_read_b64_tr_b16 v[24:25], v13 offset:49152
    v_mfma_f32_16x16x32_bf16 v[184:187], v[60:63], v[28:31], v[184:187]
    ds_read_b64_tr_b16 v[26:27], v13 offset:51200
    v_mfma_f32_16x16x32_bf16 v[180:183], v[56:59], v[28:31], v[180:183]
    v_mfma_f32_16x16x32_bf16 v[176:179], v[52:55], v[28:31], v[176:179]
    s_waitcnt lgkmcnt(2)
    v_mfma_f32_16x16x32_bf16 v[192:195], v[52:55], v[20:23], v[192:195]
    ds_read_b64_tr_b16 v[28:29], v14 offset:49152
    v_mfma_f32_16x16x32_bf16 v[196:199], v[56:59], v[20:23], v[196:199]
    ds_read_b64_tr_b16 v[30:31], v14 offset:51200
    v_mfma_f32_16x16x32_bf16 v[200:203], v[60:63], v[20:23], v[200:203]
    v_mfma_f32_16x16x32_bf16 v[204:207], v[64:67], v[20:23], v[204:207]
    s_waitcnt lgkmcnt(0)
    s_barrier
    v_mfma_f32_16x16x32_bf16 v[220:223], v[64:67], v[24:27], v[220:223]
    ds_read_b64_tr_b16 v[20:21], v8 offset:0
    ds_read_b128 v[36:39], v16 offset:0
    v_mfma_f32_16x16x32_bf16 v[216:219], v[60:63], v[24:27], v[216:219]
    ds_read_b64_tr_b16 v[22:23], v8 offset:2048
    ds_read_b128 v[40:43], v16 offset:2048
    v_mfma_f32_16x16x32_bf16 v[212:215], v[56:59], v[24:27], v[212:215]
    ds_read_b128 v[44:47], v18 offset:0
    v_mfma_f32_16x16x32_bf16 v[208:211], v[52:55], v[24:27], v[208:211]
    ds_read_b128 v[48:51], v18 offset:2048
    v_mfma_f32_16x16x32_bf16 v[224:227], v[52:55], v[28:31], v[224:227]
    ds_read_b64_tr_b16 v[24:25], v9 offset:0
    v_mfma_f32_16x16x32_bf16 v[228:231], v[56:59], v[28:31], v[228:231]
    ds_read_b64_tr_b16 v[26:27], v9 offset:2048
    v_mfma_f32_16x16x32_bf16 v[232:235], v[60:63], v[28:31], v[232:235]
    v_mfma_f32_16x16x32_bf16 v[236:239], v[64:67], v[28:31], v[236:239]
    s_waitcnt lgkmcnt(5)
    v_mfma_f32_16x16x32_bf16 v[128:131], v[36:39], v[20:23], v[128:131]
    ds_read_b64_tr_b16 v[28:29], v10 offset:0
    s_waitcnt lgkmcnt(5)
    v_mfma_f32_16x16x32_bf16 v[132:135], v[40:43], v[20:23], v[132:135]
    ds_read_b64_tr_b16 v[30:31], v10 offset:2048
    s_waitcnt lgkmcnt(5)
    v_mfma_f32_16x16x32_bf16 v[136:139], v[44:47], v[20:23], v[136:139]
    v_add_u32 v0, s21, v2
    s_waitcnt lgkmcnt(4)
    v_mfma_f32_16x16x32_bf16 v[140:143], v[48:51], v[20:23], v[140:143]
    v_xor_b32 v15, 0x1000, v0
    s_waitcnt lgkmcnt(2)
    v_mfma_f32_16x16x32_bf16 v[156:159], v[48:51], v[24:27], v[156:159]
    ds_read_b64_tr_b16 v[20:21], v11 offset:0
    v_mov_b32 v5, s57
    v_mfma_f32_16x16x32_bf16 v[152:155], v[44:47], v[24:27], v[152:155]
    ds_read_b64_tr_b16 v[22:23], v11 offset:2048
    v_mov_b32 v1, 0x80000000
    v_mfma_f32_16x16x32_bf16 v[148:151], v[40:43], v[24:27], v[148:151]
    v_cmp_eq_u32 vcc, 16, v2
    s_nop 1
    v_cndmask_b32 v1, v1, v5, vcc
    v_mfma_f32_16x16x32_bf16 v[144:147], v[36:39], v[24:27], v[144:147]
    v_mov_b32 v5, s56
    s_waitcnt lgkmcnt(2)
    v_mfma_f32_16x16x32_bf16 v[160:163], v[36:39], v[28:31], v[160:163]
    ds_read_b64_tr_b16 v[24:25], v12 offset:0
    v_cmp_eq_u32 vcc, 0, v2
    v_mfma_f32_16x16x32_bf16 v[164:167], v[40:43], v[28:31], v[164:167]
    ds_read_b64_tr_b16 v[26:27], v12 offset:2048
    v_cndmask_b32 v1, v1, v5, vcc
    v_mfma_f32_16x16x32_bf16 v[168:171], v[44:47], v[28:31], v[168:171]
    v_mfma_f32_16x16x32_bf16 v[172:175], v[48:51], v[28:31], v[172:175]
    s_waitcnt lgkmcnt(2)
    v_mfma_f32_16x16x32_bf16 v[188:191], v[48:51], v[20:23], v[188:191]
    ds_read_b64_tr_b16 v[28:29], v13 offset:0
    v_mfma_f32_16x16x32_bf16 v[184:187], v[44:47], v[20:23], v[184:187]
    ds_read_b64_tr_b16 v[30:31], v13 offset:2048
    v_mfma_f32_16x16x32_bf16 v[180:183], v[40:43], v[20:23], v[180:183]
    v_mfma_f32_16x16x32_bf16 v[176:179], v[36:39], v[20:23], v[176:179]
    s_waitcnt lgkmcnt(2)
    v_mfma_f32_16x16x32_bf16 v[192:195], v[36:39], v[24:27], v[192:195]
    ds_read_b64_tr_b16 v[20:21], v14 offset:0
    v_mfma_f32_16x16x32_bf16 v[196:199], v[40:43], v[24:27], v[196:199]
    ds_read_b64_tr_b16 v[22:23], v14 offset:2048
    v_mfma_f32_16x16x32_bf16 v[200:203], v[44:47], v[24:27], v[200:203]
    v_mfma_f32_16x16x32_bf16 v[204:207], v[48:51], v[24:27], v[204:207]
    s_waitcnt lgkmcnt(0)
    s_barrier
    v_mfma_f32_16x16x32_bf16 v[220:223], v[48:51], v[28:31], v[220:223]
    ds_read_b64_tr_b16 v[24:25], v8 offset:16384
    ds_read_b128 v[52:55], v17 offset:0
    v_mfma_f32_16x16x32_bf16 v[216:219], v[44:47], v[28:31], v[216:219]
    ds_read_b64_tr_b16 v[26:27], v8 offset:18432
    ds_read_b128 v[56:59], v17 offset:2048
    v_mfma_f32_16x16x32_bf16 v[212:215], v[40:43], v[28:31], v[212:215]
    ds_read_b128 v[60:63], v19 offset:0
    v_mfma_f32_16x16x32_bf16 v[208:211], v[36:39], v[28:31], v[208:211]
    ds_read_b128 v[64:67], v19 offset:2048
    v_mfma_f32_16x16x32_bf16 v[224:227], v[36:39], v[20:23], v[224:227]
    ds_read_b64_tr_b16 v[28:29], v9 offset:16384
    v_mfma_f32_16x16x32_bf16 v[228:231], v[40:43], v[20:23], v[228:231]
    ds_read_b64_tr_b16 v[30:31], v9 offset:18432
    v_mfma_f32_16x16x32_bf16 v[232:235], v[44:47], v[20:23], v[232:235]
    v_mfma_f32_16x16x32_bf16 v[236:239], v[48:51], v[20:23], v[236:239]
    s_waitcnt lgkmcnt(5)
    v_mfma_f32_16x16x32_bf16 v[128:131], v[52:55], v[24:27], v[128:131]
    ds_read_b64_tr_b16 v[20:21], v10 offset:16384
    s_waitcnt lgkmcnt(5)
    v_mfma_f32_16x16x32_bf16 v[132:135], v[56:59], v[24:27], v[132:135]
    ds_read_b64_tr_b16 v[22:23], v10 offset:18432
    s_waitcnt lgkmcnt(5)
    v_mfma_f32_16x16x32_bf16 v[136:139], v[60:63], v[24:27], v[136:139]
    s_waitcnt lgkmcnt(4)
    v_mfma_f32_16x16x32_bf16 v[140:143], v[64:67], v[24:27], v[140:143]
    s_waitcnt lgkmcnt(2)
    v_mfma_f32_16x16x32_bf16 v[156:159], v[64:67], v[28:31], v[156:159]
    ds_read_b64_tr_b16 v[24:25], v11 offset:16384
    v_mfma_f32_16x16x32_bf16 v[152:155], v[60:63], v[28:31], v[152:155]
    ds_read_b64_tr_b16 v[26:27], v11 offset:18432
    v_mfma_f32_16x16x32_bf16 v[148:151], v[56:59], v[28:31], v[148:151]
    v_mfma_f32_16x16x32_bf16 v[144:147], v[52:55], v[28:31], v[144:147]
    s_waitcnt lgkmcnt(2)
    v_mfma_f32_16x16x32_bf16 v[160:163], v[52:55], v[20:23], v[160:163]
    ds_read_b64_tr_b16 v[28:29], v12 offset:16384
    v_mfma_f32_16x16x32_bf16 v[164:167], v[56:59], v[20:23], v[164:167]
    ds_read_b64_tr_b16 v[30:31], v12 offset:18432
    v_mfma_f32_16x16x32_bf16 v[168:171], v[60:63], v[20:23], v[168:171]
    v_mfma_f32_16x16x32_bf16 v[172:175], v[64:67], v[20:23], v[172:175]
    s_waitcnt lgkmcnt(2)
    v_mfma_f32_16x16x32_bf16 v[188:191], v[64:67], v[24:27], v[188:191]
    ds_read_b64_tr_b16 v[20:21], v13 offset:16384
    v_mfma_f32_16x16x32_bf16 v[184:187], v[60:63], v[24:27], v[184:187]
    ds_read_b64_tr_b16 v[22:23], v13 offset:18432
    v_mfma_f32_16x16x32_bf16 v[180:183], v[56:59], v[24:27], v[180:183]
    v_mfma_f32_16x16x32_bf16 v[176:179], v[52:55], v[24:27], v[176:179]
    s_waitcnt lgkmcnt(2)
    v_mfma_f32_16x16x32_bf16 v[192:195], v[52:55], v[28:31], v[192:195]
    ds_read_b64_tr_b16 v[24:25], v14 offset:16384
    v_mfma_f32_16x16x32_bf16 v[196:199], v[56:59], v[28:31], v[196:199]
    ds_read_b64_tr_b16 v[26:27], v14 offset:18432
    v_mfma_f32_16x16x32_bf16 v[200:203], v[60:63], v[28:31], v[200:203]
    v_mfma_f32_16x16x32_bf16 v[204:207], v[64:67], v[28:31], v[204:207]
    s_waitcnt lgkmcnt(0)
    s_barrier
    v_mfma_f32_16x16x32_bf16 v[220:223], v[64:67], v[20:23], v[220:223]
    ds_read_b64_tr_b16 v[28:29], v8 offset:32768
    ds_read_b128 v[36:39], v16 offset:49152
    v_mfma_f32_16x16x32_bf16 v[216:219], v[60:63], v[20:23], v[216:219]
    ds_read_b64_tr_b16 v[30:31], v8 offset:34816
    ds_read_b128 v[40:43], v16 offset:51200
    v_mfma_f32_16x16x32_bf16 v[212:215], v[56:59], v[20:23], v[212:215]
    ds_read_b128 v[44:47], v18 offset:49152
    v_mfma_f32_16x16x32_bf16 v[208:211], v[52:55], v[20:23], v[208:211]
    ds_read_b128 v[48:51], v18 offset:51200
    v_mfma_f32_16x16x32_bf16 v[224:227], v[52:55], v[24:27], v[224:227]
    ds_read_b64_tr_b16 v[20:21], v9 offset:32768
    v_mfma_f32_16x16x32_bf16 v[228:231], v[56:59], v[24:27], v[228:231]
    ds_read_b64_tr_b16 v[22:23], v9 offset:34816
    v_mfma_f32_16x16x32_bf16 v[232:235], v[60:63], v[24:27], v[232:235]
    v_mfma_f32_16x16x32_bf16 v[236:239], v[64:67], v[24:27], v[236:239]
    s_waitcnt lgkmcnt(5)
    v_mfma_f32_16x16x32_bf16 v[128:131], v[36:39], v[28:31], v[128:131]
    ds_read_b64_tr_b16 v[24:25], v10 offset:32768
    s_waitcnt lgkmcnt(5)
    v_mfma_f32_16x16x32_bf16 v[132:135], v[40:43], v[28:31], v[132:135]
    ds_read_b64_tr_b16 v[26:27], v10 offset:34816
    s_waitcnt lgkmcnt(5)
    v_mfma_f32_16x16x32_bf16 v[136:139], v[44:47], v[28:31], v[136:139]
    s_waitcnt lgkmcnt(4)
    v_mfma_f32_16x16x32_bf16 v[140:143], v[48:51], v[28:31], v[140:143]
    s_waitcnt lgkmcnt(2)
    v_mfma_f32_16x16x32_bf16 v[156:159], v[48:51], v[20:23], v[156:159]
    ds_read_b64_tr_b16 v[28:29], v11 offset:32768
    v_mfma_f32_16x16x32_bf16 v[152:155], v[44:47], v[20:23], v[152:155]
    ds_read_b64_tr_b16 v[30:31], v11 offset:34816
    v_mfma_f32_16x16x32_bf16 v[148:151], v[40:43], v[20:23], v[148:151]
    v_mfma_f32_16x16x32_bf16 v[144:147], v[36:39], v[20:23], v[144:147]
    s_waitcnt lgkmcnt(2)
    v_mfma_f32_16x16x32_bf16 v[160:163], v[36:39], v[24:27], v[160:163]
    ds_read_b64_tr_b16 v[20:21], v12 offset:32768
    v_mfma_f32_16x16x32_bf16 v[164:167], v[40:43], v[24:27], v[164:167]
    ds_read_b64_tr_b16 v[22:23], v12 offset:34816
    v_mfma_f32_16x16x32_bf16 v[168:171], v[44:47], v[24:27], v[168:171]
    v_mfma_f32_16x16x32_bf16 v[172:175], v[48:51], v[24:27], v[172:175]
    s_waitcnt lgkmcnt(2)
    v_mfma_f32_16x16x32_bf16 v[188:191], v[48:51], v[28:31], v[188:191]
    ds_read_b64_tr_b16 v[24:25], v13 offset:32768
    v_mfma_f32_16x16x32_bf16 v[184:187], v[44:47], v[28:31], v[184:187]
    ds_read_b64_tr_b16 v[26:27], v13 offset:34816
    v_mfma_f32_16x16x32_bf16 v[180:183], v[40:43], v[28:31], v[180:183]
    v_mfma_f32_16x16x32_bf16 v[176:179], v[36:39], v[28:31], v[176:179]
    s_waitcnt lgkmcnt(2)
    v_mfma_f32_16x16x32_bf16 v[192:195], v[36:39], v[20:23], v[192:195]
    ds_read_b64_tr_b16 v[28:29], v14 offset:32768
    v_mfma_f32_16x16x32_bf16 v[196:199], v[40:43], v[20:23], v[196:199]
    ds_read_b64_tr_b16 v[30:31], v14 offset:34816
    v_mfma_f32_16x16x32_bf16 v[200:203], v[44:47], v[20:23], v[200:203]
    v_mfma_f32_16x16x32_bf16 v[204:207], v[48:51], v[20:23], v[204:207]
    s_waitcnt lgkmcnt(0)
    s_barrier
    v_mfma_f32_16x16x32_bf16 v[220:223], v[48:51], v[24:27], v[220:223]
    ds_read_b64_tr_b16 v[20:21], v8 offset:49152
    ds_read_b128 v[52:55], v17 offset:49152
    v_mfma_f32_16x16x32_bf16 v[216:219], v[44:47], v[24:27], v[216:219]
    ds_read_b64_tr_b16 v[22:23], v8 offset:51200
    ds_read_b128 v[56:59], v17 offset:51200
    v_mfma_f32_16x16x32_bf16 v[212:215], v[40:43], v[24:27], v[212:215]
    ds_read_b128 v[60:63], v19 offset:49152
    v_mfma_f32_16x16x32_bf16 v[208:211], v[36:39], v[24:27], v[208:211]
    ds_read_b128 v[64:67], v19 offset:51200
    v_mfma_f32_16x16x32_bf16 v[224:227], v[36:39], v[28:31], v[224:227]
    ds_read_b64_tr_b16 v[24:25], v9 offset:49152
    v_mfma_f32_16x16x32_bf16 v[228:231], v[40:43], v[28:31], v[228:231]
    ds_read_b64_tr_b16 v[26:27], v9 offset:51200
    v_mfma_f32_16x16x32_bf16 v[232:235], v[44:47], v[28:31], v[232:235]
    v_mfma_f32_16x16x32_bf16 v[236:239], v[48:51], v[28:31], v[236:239]
    s_waitcnt lgkmcnt(5)
    v_mfma_f32_16x16x32_bf16 v[128:131], v[52:55], v[20:23], v[128:131]
    ds_read_b64_tr_b16 v[28:29], v10 offset:49152
    s_waitcnt lgkmcnt(5)
    v_mfma_f32_16x16x32_bf16 v[132:135], v[56:59], v[20:23], v[132:135]
    ds_read_b64_tr_b16 v[30:31], v10 offset:51200
    s_waitcnt lgkmcnt(5)
    v_mfma_f32_16x16x32_bf16 v[136:139], v[60:63], v[20:23], v[136:139]
    s_waitcnt lgkmcnt(4)
    v_mfma_f32_16x16x32_bf16 v[140:143], v[64:67], v[20:23], v[140:143]
    s_waitcnt lgkmcnt(2)
    v_mfma_f32_16x16x32_bf16 v[156:159], v[64:67], v[24:27], v[156:159]
    ds_read_b64_tr_b16 v[20:21], v11 offset:49152
    v_mfma_f32_16x16x32_bf16 v[152:155], v[60:63], v[24:27], v[152:155]
    ds_read_b64_tr_b16 v[22:23], v11 offset:51200
    v_mfma_f32_16x16x32_bf16 v[148:151], v[56:59], v[24:27], v[148:151]
    v_mfma_f32_16x16x32_bf16 v[144:147], v[52:55], v[24:27], v[144:147]
    s_waitcnt lgkmcnt(2)
    v_mfma_f32_16x16x32_bf16 v[160:163], v[52:55], v[28:31], v[160:163]
    ds_read_b64_tr_b16 v[24:25], v12 offset:49152
    v_mfma_f32_16x16x32_bf16 v[164:167], v[56:59], v[28:31], v[164:167]
    ds_read_b64_tr_b16 v[26:27], v12 offset:51200
    v_mfma_f32_16x16x32_bf16 v[168:171], v[60:63], v[28:31], v[168:171]
    v_mfma_f32_16x16x32_bf16 v[172:175], v[64:67], v[28:31], v[172:175]
    s_waitcnt lgkmcnt(2)
    v_mfma_f32_16x16x32_bf16 v[188:191], v[64:67], v[20:23], v[188:191]
    ds_read_b64_tr_b16 v[28:29], v13 offset:49152
    v_mfma_f32_16x16x32_bf16 v[184:187], v[60:63], v[20:23], v[184:187]
    ds_read_b64_tr_b16 v[30:31], v13 offset:51200
    v_mfma_f32_16x16x32_bf16 v[180:183], v[56:59], v[20:23], v[180:183]
    v_mfma_f32_16x16x32_bf16 v[176:179], v[52:55], v[20:23], v[176:179]
    s_waitcnt lgkmcnt(2)
    v_mfma_f32_16x16x32_bf16 v[192:195], v[52:55], v[24:27], v[192:195]
    ds_read_b64_tr_b16 v[20:21], v14 offset:49152
    v_mfma_f32_16x16x32_bf16 v[196:199], v[56:59], v[24:27], v[196:199]
    ds_read_b64_tr_b16 v[22:23], v14 offset:51200
    v_mfma_f32_16x16x32_bf16 v[200:203], v[60:63], v[24:27], v[200:203]
    v_mfma_f32_16x16x32_bf16 v[204:207], v[64:67], v[24:27], v[204:207]
    s_waitcnt lgkmcnt(0)
    s_barrier
    v_mfma_f32_16x16x32_bf16 v[220:223], v[64:67], v[28:31], v[220:223]
    ds_read_b64_tr_b16 v[24:25], v8 offset:0
    ds_read_b128 v[36:39], v16 offset:32768
    v_mfma_f32_16x16x32_bf16 v[216:219], v[60:63], v[28:31], v[216:219]
    ds_read_b64_tr_b16 v[26:27], v8 offset:2048
    ds_read_b128 v[40:43], v16 offset:34816
    v_mfma_f32_16x16x32_bf16 v[212:215], v[56:59], v[28:31], v[212:215]
    ds_read_b128 v[44:47], v18 offset:32768
    v_mfma_f32_16x16x32_bf16 v[208:211], v[52:55], v[28:31], v[208:211]
    ds_read_b128 v[48:51], v18 offset:34816
    v_mfma_f32_16x16x32_bf16 v[224:227], v[52:55], v[20:23], v[224:227]
    ds_read_b64_tr_b16 v[28:29], v9 offset:0
    v_mfma_f32_16x16x32_bf16 v[228:231], v[56:59], v[20:23], v[228:231]
    ds_read_b64_tr_b16 v[30:31], v9 offset:2048
    v_mfma_f32_16x16x32_bf16 v[232:235], v[60:63], v[20:23], v[232:235]
    v_mfma_f32_16x16x32_bf16 v[236:239], v[64:67], v[20:23], v[236:239]
    s_waitcnt lgkmcnt(5)
    v_mfma_f32_16x16x32_bf16 v[128:131], v[36:39], v[24:27], v[128:131]
    ds_read_b64_tr_b16 v[20:21], v10 offset:0
    s_waitcnt lgkmcnt(5)
    v_mfma_f32_16x16x32_bf16 v[132:135], v[40:43], v[24:27], v[132:135]
    ds_read_b64_tr_b16 v[22:23], v10 offset:2048
    s_waitcnt lgkmcnt(5)
    v_mfma_f32_16x16x32_bf16 v[136:139], v[44:47], v[24:27], v[136:139]
    s_waitcnt lgkmcnt(4)
    v_mfma_f32_16x16x32_bf16 v[140:143], v[48:51], v[24:27], v[140:143]
    s_waitcnt lgkmcnt(2)
    v_mfma_f32_16x16x32_bf16 v[156:159], v[48:51], v[28:31], v[156:159]
    ds_read_b64_tr_b16 v[24:25], v11 offset:0
    v_mfma_f32_16x16x32_bf16 v[152:155], v[44:47], v[28:31], v[152:155]
    ds_read_b64_tr_b16 v[26:27], v11 offset:2048
    v_mfma_f32_16x16x32_bf16 v[148:151], v[40:43], v[28:31], v[148:151]
    v_mfma_f32_16x16x32_bf16 v[144:147], v[36:39], v[28:31], v[144:147]
    s_waitcnt lgkmcnt(2)
    v_mfma_f32_16x16x32_bf16 v[160:163], v[36:39], v[20:23], v[160:163]
    ds_read_b64_tr_b16 v[28:29], v12 offset:0
    v_mfma_f32_16x16x32_bf16 v[164:167], v[40:43], v[20:23], v[164:167]
    ds_read_b64_tr_b16 v[30:31], v12 offset:2048
    v_mfma_f32_16x16x32_bf16 v[168:171], v[44:47], v[20:23], v[168:171]
    v_mfma_f32_16x16x32_bf16 v[172:175], v[48:51], v[20:23], v[172:175]
    s_waitcnt lgkmcnt(2)
    v_mfma_f32_16x16x32_bf16 v[188:191], v[48:51], v[24:27], v[188:191]
    ds_read_b64_tr_b16 v[20:21], v13 offset:0
    v_mfma_f32_16x16x32_bf16 v[184:187], v[44:47], v[24:27], v[184:187]
    ds_read_b64_tr_b16 v[22:23], v13 offset:2048
    v_mfma_f32_16x16x32_bf16 v[180:183], v[40:43], v[24:27], v[180:183]
    v_mfma_f32_16x16x32_bf16 v[176:179], v[36:39], v[24:27], v[176:179]
    s_waitcnt lgkmcnt(2)
    v_mfma_f32_16x16x32_bf16 v[192:195], v[36:39], v[28:31], v[192:195]
    ds_read_b64_tr_b16 v[24:25], v14 offset:0
    v_mfma_f32_16x16x32_bf16 v[196:199], v[40:43], v[28:31], v[196:199]
    ds_read_b64_tr_b16 v[26:27], v14 offset:2048
    v_mfma_f32_16x16x32_bf16 v[200:203], v[44:47], v[28:31], v[200:203]
    v_mfma_f32_16x16x32_bf16 v[204:207], v[48:51], v[28:31], v[204:207]
    s_barrier
    s_waitcnt lgkmcnt(2)
    v_mfma_f32_16x16x32_bf16 v[220:223], v[48:51], v[20:23], v[220:223]
    ds_read_b64_tr_b16 v[28:29], v8 offset:16384
    ds_read_b128 v[52:55], v17 offset:32768
    v_mfma_f32_16x16x32_bf16 v[216:219], v[44:47], v[20:23], v[216:219]
    ds_read_b64_tr_b16 v[30:31], v8 offset:18432
    ds_read_b128 v[56:59], v17 offset:34816
    v_mfma_f32_16x16x32_bf16 v[212:215], v[40:43], v[20:23], v[212:215]
    ds_read_b128 v[60:63], v19 offset:32768
    v_mfma_f32_16x16x32_bf16 v[208:211], v[36:39], v[20:23], v[208:211]
    ds_read_b128 v[64:67], v19 offset:34816
    s_waitcnt lgkmcnt(6)
    v_mfma_f32_16x16x32_bf16 v[224:227], v[36:39], v[24:27], v[224:227]
    ds_read_b64_tr_b16 v[20:21], v9 offset:16384
    v_mfma_f32_16x16x32_bf16 v[228:231], v[40:43], v[24:27], v[228:231]
    ds_read_b64_tr_b16 v[22:23], v9 offset:18432
    v_mfma_f32_16x16x32_bf16 v[232:235], v[44:47], v[24:27], v[232:235]
    v_mfma_f32_16x16x32_bf16 v[236:239], v[48:51], v[24:27], v[236:239]
    s_waitcnt lgkmcnt(5)
    v_mfma_f32_16x16x32_bf16 v[128:131], v[52:55], v[28:31], v[128:131]
    ds_read_b64_tr_b16 v[24:25], v10 offset:16384
    s_waitcnt lgkmcnt(5)
    v_mfma_f32_16x16x32_bf16 v[132:135], v[56:59], v[28:31], v[132:135]
    ds_read_b64_tr_b16 v[26:27], v10 offset:18432
    s_waitcnt lgkmcnt(5)
    v_mfma_f32_16x16x32_bf16 v[136:139], v[60:63], v[28:31], v[136:139]
    s_waitcnt lgkmcnt(4)
    v_mfma_f32_16x16x32_bf16 v[140:143], v[64:67], v[28:31], v[140:143]
    s_waitcnt lgkmcnt(2)
    v_mfma_f32_16x16x32_bf16 v[156:159], v[64:67], v[20:23], v[156:159]
    ds_read_b64_tr_b16 v[28:29], v11 offset:16384
    v_mfma_f32_16x16x32_bf16 v[152:155], v[60:63], v[20:23], v[152:155]
    ds_read_b64_tr_b16 v[30:31], v11 offset:18432
    v_mfma_f32_16x16x32_bf16 v[148:151], v[56:59], v[20:23], v[148:151]
    v_cvt_pk_bf16_f32 v68, v128, v129
    v_cvt_pk_bf16_f32 v69, v130, v131
    v_mfma_f32_16x16x32_bf16 v[144:147], v[52:55], v[20:23], v[144:147]
    v_cvt_pk_bf16_f32 v70, v132, v133
    s_waitcnt lgkmcnt(2)
    v_mfma_f32_16x16x32_bf16 v[160:163], v[52:55], v[24:27], v[160:163]
    ds_read_b64_tr_b16 v[20:21], v12 offset:16384
    v_cvt_pk_bf16_f32 v71, v134, v135
    v_mfma_f32_16x16x32_bf16 v[164:167], v[56:59], v[24:27], v[164:167]
    ds_read_b64_tr_b16 v[22:23], v12 offset:18432
    v_cvt_pk_bf16_f32 v96, v136, v137
    v_mfma_f32_16x16x32_bf16 v[168:171], v[60:63], v[24:27], v[168:171]
    v_cvt_pk_bf16_f32 v97, v138, v139
    v_cvt_pk_bf16_f32 v98, v140, v141
    v_mfma_f32_16x16x32_bf16 v[172:175], v[64:67], v[24:27], v[172:175]
    v_cvt_pk_bf16_f32 v99, v142, v143
    s_waitcnt lgkmcnt(2)
    v_mfma_f32_16x16x32_bf16 v[188:191], v[64:67], v[28:31], v[188:191]
    ds_read_b64_tr_b16 v[24:25], v13 offset:16384
    v_cvt_pk_bf16_f32 v72, v144, v145
    v_mfma_f32_16x16x32_bf16 v[184:187], v[60:63], v[28:31], v[184:187]
    ds_read_b64_tr_b16 v[26:27], v13 offset:18432
    v_cvt_pk_bf16_f32 v73, v146, v147
    v_mfma_f32_16x16x32_bf16 v[180:183], v[56:59], v[28:31], v[180:183]
    v_cvt_pk_bf16_f32 v74, v148, v149
    v_cvt_pk_bf16_f32 v75, v150, v151
    v_mfma_f32_16x16x32_bf16 v[176:179], v[52:55], v[28:31], v[176:179]
    v_cvt_pk_bf16_f32 v100, v152, v153
    s_waitcnt lgkmcnt(2)
    v_mfma_f32_16x16x32_bf16 v[192:195], v[52:55], v[20:23], v[192:195]
    ds_read_b64_tr_b16 v[28:29], v14 offset:16384
    v_cvt_pk_bf16_f32 v101, v154, v155
    v_mfma_f32_16x16x32_bf16 v[196:199], v[56:59], v[20:23], v[196:199]
    ds_read_b64_tr_b16 v[30:31], v14 offset:18432
    v_cvt_pk_bf16_f32 v102, v156, v157
    v_mfma_f32_16x16x32_bf16 v[200:203], v[60:63], v[20:23], v[200:203]
    v_cvt_pk_bf16_f32 v103, v158, v159
    v_cvt_pk_bf16_f32 v76, v160, v161
    v_mfma_f32_16x16x32_bf16 v[204:207], v[64:67], v[20:23], v[204:207]
    s_barrier
    s_waitcnt lgkmcnt(2)
    v_mfma_f32_16x16x32_bf16 v[220:223], v[64:67], v[24:27], v[220:223]
    ds_read_b64_tr_b16 v[20:21], v8 offset:32768
    ds_read_b128 v[36:39], v16 offset:16384
    v_mfma_f32_16x16x32_bf16 v[216:219], v[60:63], v[24:27], v[216:219]
    ds_read_b64_tr_b16 v[22:23], v8 offset:34816
    ds_read_b128 v[40:43], v16 offset:18432
    v_mfma_f32_16x16x32_bf16 v[212:215], v[56:59], v[24:27], v[212:215]
    ds_read_b128 v[44:47], v18 offset:16384
    v_cvt_pk_bf16_f32 v77, v162, v163
    v_mfma_f32_16x16x32_bf16 v[208:211], v[52:55], v[24:27], v[208:211]
    ds_read_b128 v[48:51], v18 offset:18432
    s_waitcnt lgkmcnt(6)
    v_mfma_f32_16x16x32_bf16 v[224:227], v[52:55], v[28:31], v[224:227]
    ds_read_b64_tr_b16 v[24:25], v9 offset:32768
    v_cvt_pk_bf16_f32 v78, v164, v165
    v_mfma_f32_16x16x32_bf16 v[228:231], v[56:59], v[28:31], v[228:231]
    ds_read_b64_tr_b16 v[26:27], v9 offset:34816
    v_cvt_pk_bf16_f32 v79, v166, v167
    v_mfma_f32_16x16x32_bf16 v[232:235], v[60:63], v[28:31], v[232:235]
    v_cvt_pk_bf16_f32 v104, v168, v169
    v_cvt_pk_bf16_f32 v105, v170, v171
    v_mfma_f32_16x16x32_bf16 v[236:239], v[64:67], v[28:31], v[236:239]
    v_cvt_pk_bf16_f32 v106, v172, v173
    s_waitcnt lgkmcnt(5)
    v_mfma_f32_16x16x32_bf16 v[128:131], v[36:39], v[20:23], 0
    ds_read_b64_tr_b16 v[28:29], v10 offset:32768
    s_waitcnt lgkmcnt(5)
    v_mfma_f32_16x16x32_bf16 v[132:135], v[40:43], v[20:23], 0
    ds_read_b64_tr_b16 v[30:31], v10 offset:34816
    s_waitcnt lgkmcnt(5)
    v_mfma_f32_16x16x32_bf16 v[136:139], v[44:47], v[20:23], 0
    v_cvt_pk_bf16_f32 v107, v174, v175
    s_waitcnt lgkmcnt(4)
    v_mfma_f32_16x16x32_bf16 v[140:143], v[48:51], v[20:23], 0
    v_cvt_pk_bf16_f32 v80, v176, v177
    s_waitcnt lgkmcnt(2)
    v_mfma_f32_16x16x32_bf16 v[156:159], v[48:51], v[24:27], 0
    ds_read_b64_tr_b16 v[20:21], v11 offset:32768
    v_cvt_pk_bf16_f32 v81, v178, v179
    v_mfma_f32_16x16x32_bf16 v[152:155], v[44:47], v[24:27], 0
    ds_read_b64_tr_b16 v[22:23], v11 offset:34816
    v_cvt_pk_bf16_f32 v82, v180, v181
    v_mfma_f32_16x16x32_bf16 v[148:151], v[40:43], v[24:27], 0
    v_cvt_pk_bf16_f32 v83, v182, v183
    v_cvt_pk_bf16_f32 v108, v184, v185
    v_mfma_f32_16x16x32_bf16 v[144:147], v[36:39], v[24:27], 0
    v_cvt_pk_bf16_f32 v109, v186, v187
    s_waitcnt lgkmcnt(2)
    v_mfma_f32_16x16x32_bf16 v[160:163], v[36:39], v[28:31], 0
    ds_read_b64_tr_b16 v[24:25], v12 offset:32768
    v_cvt_pk_bf16_f32 v110, v188, v189
    v_mfma_f32_16x16x32_bf16 v[164:167], v[40:43], v[28:31], 0
    ds_read_b64_tr_b16 v[26:27], v12 offset:34816
    v_cvt_pk_bf16_f32 v111, v190, v191
    v_mfma_f32_16x16x32_bf16 v[168:171], v[44:47], v[28:31], 0
    v_cvt_pk_bf16_f32 v84, v192, v193
    v_cvt_pk_bf16_f32 v85, v194, v195
    v_mfma_f32_16x16x32_bf16 v[172:175], v[48:51], v[28:31], 0
    v_cvt_pk_bf16_f32 v86, v196, v197
    s_waitcnt lgkmcnt(2)
    v_mfma_f32_16x16x32_bf16 v[188:191], v[48:51], v[20:23], 0
    ds_read_b64_tr_b16 v[28:29], v13 offset:32768
    v_cvt_pk_bf16_f32 v87, v198, v199
    v_mfma_f32_16x16x32_bf16 v[184:187], v[44:47], v[20:23], 0
    ds_read_b64_tr_b16 v[30:31], v13 offset:34816
    v_cvt_pk_bf16_f32 v112, v200, v201
    v_mfma_f32_16x16x32_bf16 v[180:183], v[40:43], v[20:23], 0
    v_cvt_pk_bf16_f32 v113, v202, v203
    v_cvt_pk_bf16_f32 v114, v204, v205
    v_mfma_f32_16x16x32_bf16 v[176:179], v[36:39], v[20:23], 0
    v_cvt_pk_bf16_f32 v115, v206, v207
    s_waitcnt lgkmcnt(2)
    v_mfma_f32_16x16x32_bf16 v[192:195], v[36:39], v[24:27], 0
    ds_read_b64_tr_b16 v[20:21], v14 offset:32768
    v_cvt_pk_bf16_f32 v88, v208, v209
    v_mfma_f32_16x16x32_bf16 v[196:199], v[40:43], v[24:27], 0
    ds_read_b64_tr_b16 v[22:23], v14 offset:34816
    v_cvt_pk_bf16_f32 v89, v210, v211
    v_mfma_f32_16x16x32_bf16 v[200:203], v[44:47], v[24:27], 0
    v_cvt_pk_bf16_f32 v90, v212, v213
    v_cvt_pk_bf16_f32 v91, v214, v215
    v_mfma_f32_16x16x32_bf16 v[204:207], v[48:51], v[24:27], 0
    s_barrier
    v_cvt_pk_bf16_f32 v116, v216, v217
    v_cvt_pk_bf16_f32 v117, v218, v219
    v_cvt_pk_bf16_f32 v118, v220, v221
    v_cvt_pk_bf16_f32 v119, v222, v223
    s_waitcnt lgkmcnt(2)
    v_mfma_f32_16x16x32_bf16 v[220:223], v[48:51], v[28:31], 0
    ds_read_b64_tr_b16 v[24:25], v8 offset:49152
    ds_read_b128 v[52:55], v17 offset:16384
    v_mfma_f32_16x16x32_bf16 v[216:219], v[44:47], v[28:31], 0
    ds_read_b64_tr_b16 v[26:27], v8 offset:51200
    ds_read_b128 v[56:59], v17 offset:18432
    v_mfma_f32_16x16x32_bf16 v[212:215], v[40:43], v[28:31], 0
    ds_read_b128 v[60:63], v19 offset:16384
    v_cvt_pk_bf16_f32 v92, v224, v225
    v_mfma_f32_16x16x32_bf16 v[208:211], v[36:39], v[28:31], 0
    v_cvt_pk_bf16_f32 v93, v226, v227
    v_cvt_pk_bf16_f32 v94, v228, v229
    v_cvt_pk_bf16_f32 v95, v230, v231
    v_cvt_pk_bf16_f32 v120, v232, v233
    v_cvt_pk_bf16_f32 v121, v234, v235
    v_cvt_pk_bf16_f32 v122, v236, v237
    v_cvt_pk_bf16_f32 v123, v238, v239
    s_waitcnt lgkmcnt(5)
    v_mfma_f32_16x16x32_bf16 v[224:227], v[36:39], v[20:23], 0
    ds_read_b128 v[64:67], v19 offset:18432
    ds_read_b64_tr_b16 v[28:29], v9 offset:49152
    v_mfma_f32_16x16x32_bf16 v[228:231], v[40:43], v[20:23], 0
    ds_read_b64_tr_b16 v[30:31], v9 offset:51200
    v_mfma_f32_16x16x32_bf16 v[232:235], v[44:47], v[20:23], 0
    v_mfma_f32_16x16x32_bf16 v[236:239], v[48:51], v[20:23], 0
    s_waitcnt lgkmcnt(5)
    v_mfma_f32_16x16x32_bf16 v[128:131], v[52:55], v[24:27], v[128:131]
    ds_read_b64_tr_b16 v[20:21], v10 offset:49152
    s_waitcnt lgkmcnt(5)
    v_mfma_f32_16x16x32_bf16 v[132:135], v[56:59], v[24:27], v[132:135]
    ds_read_b64_tr_b16 v[22:23], v10 offset:51200
    s_waitcnt lgkmcnt(5)
    v_mfma_f32_16x16x32_bf16 v[136:139], v[60:63], v[24:27], v[136:139]
    s_waitcnt lgkmcnt(4)
    v_mfma_f32_16x16x32_bf16 v[140:143], v[64:67], v[24:27], v[140:143]
    s_waitcnt lgkmcnt(2)
    v_mfma_f32_16x16x32_bf16 v[156:159], v[64:67], v[28:31], v[156:159]
    ds_read_b64_tr_b16 v[24:25], v11 offset:49152
    v_mfma_f32_16x16x32_bf16 v[152:155], v[60:63], v[28:31], v[152:155]
    ds_read_b64_tr_b16 v[26:27], v11 offset:51200
    v_mfma_f32_16x16x32_bf16 v[148:151], v[56:59], v[28:31], v[148:151]
    v_mfma_f32_16x16x32_bf16 v[144:147], v[52:55], v[28:31], v[144:147]
    s_waitcnt lgkmcnt(2)
    v_mfma_f32_16x16x32_bf16 v[160:163], v[52:55], v[20:23], v[160:163]
    ds_read_b64_tr_b16 v[28:29], v12 offset:49152
    v_mfma_f32_16x16x32_bf16 v[164:167], v[56:59], v[20:23], v[164:167]
    ds_read_b64_tr_b16 v[30:31], v12 offset:51200
    v_mfma_f32_16x16x32_bf16 v[168:171], v[60:63], v[20:23], v[168:171]
    v_mfma_f32_16x16x32_bf16 v[172:175], v[64:67], v[20:23], v[172:175]
    s_waitcnt lgkmcnt(2)
    v_mfma_f32_16x16x32_bf16 v[188:191], v[64:67], v[24:27], v[188:191]
    ds_read_b64_tr_b16 v[20:21], v13 offset:49152
    v_mfma_f32_16x16x32_bf16 v[184:187], v[60:63], v[24:27], v[184:187]
    ds_read_b64_tr_b16 v[22:23], v13 offset:51200
    v_mfma_f32_16x16x32_bf16 v[180:183], v[56:59], v[24:27], v[180:183]
    v_mfma_f32_16x16x32_bf16 v[176:179], v[52:55], v[24:27], v[176:179]
    s_waitcnt lgkmcnt(2)
    v_mfma_f32_16x16x32_bf16 v[192:195], v[52:55], v[28:31], v[192:195]
    ds_read_b64_tr_b16 v[24:25], v14 offset:49152
    v_mfma_f32_16x16x32_bf16 v[196:199], v[56:59], v[28:31], v[196:199]
    ds_read_b64_tr_b16 v[26:27], v14 offset:51200
    v_mfma_f32_16x16x32_bf16 v[200:203], v[60:63], v[28:31], v[200:203]
    v_mfma_f32_16x16x32_bf16 v[204:207], v[64:67], v[28:31], v[204:207]
    s_barrier
    s_waitcnt lgkmcnt(2)
    v_mfma_f32_16x16x32_bf16 v[220:223], v[64:67], v[20:23], v[220:223]
    ds_read_b64_tr_b16 v[28:29], v8 offset:0
    ds_read_b128 v[36:39], v16 offset:0
    v_mfma_f32_16x16x32_bf16 v[216:219], v[60:63], v[20:23], v[216:219]
    ds_read_b64_tr_b16 v[30:31], v8 offset:2048
    ds_read_b128 v[40:43], v16 offset:2048
    v_mfma_f32_16x16x32_bf16 v[212:215], v[56:59], v[20:23], v[212:215]
    ds_read_b128 v[44:47], v18 offset:0
    v_mfma_f32_16x16x32_bf16 v[208:211], v[52:55], v[20:23], v[208:211]
    ds_read_b128 v[48:51], v18 offset:2048
    s_waitcnt lgkmcnt(6)
    v_mfma_f32_16x16x32_bf16 v[224:227], v[52:55], v[24:27], v[224:227]
    ds_read_b64_tr_b16 v[20:21], v9 offset:0
    v_mfma_f32_16x16x32_bf16 v[228:231], v[56:59], v[24:27], v[228:231]
    ds_read_b64_tr_b16 v[22:23], v9 offset:2048
    v_mfma_f32_16x16x32_bf16 v[232:235], v[60:63], v[24:27], v[232:235]
    v_mfma_f32_16x16x32_bf16 v[236:239], v[64:67], v[24:27], v[236:239]
    s_waitcnt lgkmcnt(5)
    v_mfma_f32_16x16x32_bf16 v[128:131], v[36:39], v[28:31], v[128:131]
    ds_read_b64_tr_b16 v[24:25], v10 offset:0
    s_waitcnt lgkmcnt(5)
    v_mfma_f32_16x16x32_bf16 v[132:135], v[40:43], v[28:31], v[132:135]
    ds_read_b64_tr_b16 v[26:27], v10 offset:2048
    s_waitcnt lgkmcnt(5)
    v_mfma_f32_16x16x32_bf16 v[136:139], v[44:47], v[28:31], v[136:139]
    s_waitcnt lgkmcnt(4)
    v_mfma_f32_16x16x32_bf16 v[140:143], v[48:51], v[28:31], v[140:143]
L_pg4:
    s_cbranch_execz L_pgback
    s_waitcnt lgkmcnt(2)
    v_mfma_f32_16x16x32_bf16 v[156:159], v[48:51], v[20:23], v[156:159]
    ds_read_b64_tr_b16 v[28:29], v11 offset:0
    v_mfma_f32_16x16x32_bf16 v[152:155], v[44:47], v[20:23], v[152:155]
    ds_read_b64_tr_b16 v[30:31], v11 offset:2048
    v_mfma_f32_16x16x32_bf16 v[148:151], v[40:43], v[20:23], v[148:151]
    v_mfma_f32_16x16x32_bf16 v[144:147], v[36:39], v[20:23], v[144:147]
    s_waitcnt lgkmcnt(2)
    v_mfma_f32_16x16x32_bf16 v[160:163], v[36:39], v[24:27], v[160:163]
    ds_read_b64_tr_b16 v[20:21], v12 offset:0
    v_mfma_f32_16x16x32_bf16 v[164:167], v[40:43], v[24:27], v[164:167]
    ds_read_b64_tr_b16 v[22:23], v12 offset:2048
    v_mfma_f32_16x16x32_bf16 v[168:171], v[44:47], v[24:27], v[168:171]
    v_mfma_f32_16x16x32_bf16 v[172:175], v[48:51], v[24:27], v[172:175]
    s_waitcnt lgkmcnt(2)
    v_mfma_f32_16x16x32_bf16 v[188:191], v[48:51], v[28:31], v[188:191]
    ds_read_b64_tr_b16 v[24:25], v13 offset:0
    v_mfma_f32_16x16x32_bf16 v[184:187], v[44:47], v[28:31], v[184:187]
    ds_read_b64_tr_b16 v[26:27], v13 offset:2048
    v_mfma_f32_16x16x32_bf16 v[180:183], v[40:43], v[28:31], v[180:183]
    v_mfma_f32_16x16x32_bf16 v[176:179], v[36:39], v[28:31], v[176:179]
    s_waitcnt lgkmcnt(2)
    v_mfma_f32_16x16x32_bf16 v[192:195], v[36:39], v[20:23], v[192:195]
    ds_read_b64_tr_b16 v[28:29], v14 offset:0
    v_mfma_f32_16x16x32_bf16 v[196:199], v[40:43], v[20:23], v[196:199]
    ds_read_b64_tr_b16 v[30:31], v14 offset:2048
    v_mfma_f32_16x16x32_bf16 v[200:203], v[44:47], v[20:23], v[200:203]
    v_mfma_f32_16x16x32_bf16 v[204:207], v[48:51], v[20:23], v[204:207]
    s_barrier
    s_waitcnt lgkmcnt(2)
    v_mfma_f32_16x16x32_bf16 v[220:223], v[48:51], v[24:27], v[220:223]
    ds_read_b64_tr_b16 v[20:21], v8 offset:16384
    ds_read_b128 v[52:55], v17 offset:0
    v_mfma_f32_16x16x32_bf16 v[216:219], v[44:47], v[24:27], v[216:219]
    ds_read_b64_tr_b16 v[22:23], v8 offset:18432
    ds_read_b128 v[56:59], v17 offset:2048
    v_mfma_f32_16x16x32_bf16 v[212:215], v[40:43], v[24:27], v[212:215]
    ds_read_b128 v[60:63], v19 offset:0
    v_mfma_f32_16x16x32_bf16 v[208:211], v[36:39], v[24:27], v[208:211]
    ds_read_b128 v[64:67], v19 offset:2048
    s_waitcnt lgkmcnt(6)
    v_mfma_f32_16x16x32_bf16 v[224:227], v[36:39], v[28:31], v[224:227]
    ds_read_b64_tr_b16 v[24:25], v9 offset:16384
    v_mfma_f32_16x16x32_bf16 v[228:231], v[40:43], v[28:31], v[228:231]
    ds_read_b64_tr_b16 v[26:27], v9 offset:18432
    v_mfma_f32_16x16x32_bf16 v[232:235], v[44:47], v[28:31], v[232:235]
    v_mfma_f32_16x16x32_bf16 v[236:239], v[48:51], v[28:31], v[236:239]
    s_waitcnt lgkmcnt(5)
    v_mfma_f32_16x16x32_bf16 v[128:131], v[52:55], v[20:23], v[128:131]
    ds_read_b64_tr_b16 v[28:29], v10 offset:16384
    s_waitcnt lgkmcnt(5)
    v_mfma_f32_16x16x32_bf16 v[132:135], v[56:59], v[20:23], v[132:135]
    ds_read_b64_tr_b16 v[30:31], v10 offset:18432
    s_waitcnt lgkmcnt(5)
    v_mfma_f32_16x16x32_bf16 v[136:139], v[60:63], v[20:23], v[136:139]
    s_waitcnt lgkmcnt(4)
    v_mfma_f32_16x16x32_bf16 v[140:143], v[64:67], v[20:23], v[140:143]
    s_waitcnt lgkmcnt(2)
    v_mfma_f32_16x16x32_bf16 v[156:159], v[64:67], v[24:27], v[156:159]
    ds_read_b64_tr_b16 v[20:21], v11 offset:16384
    v_mfma_f32_16x16x32_bf16 v[152:155], v[60:63], v[24:27], v[152:155]
    ds_read_b64_tr_b16 v[22:23], v11 offset:18432
    v_mfma_f32_16x16x32_bf16 v[148:151], v[56:59], v[24:27], v[148:151]
    v_mfma_f32_16x16x32_bf16 v[144:147], v[52:55], v[24:27], v[144:147]
    s_waitcnt lgkmcnt(2)
    v_mfma_f32_16x16x32_bf16 v[160:163], v[52:55], v[28:31], v[160:163]
    ds_read_b64_tr_b16 v[24:25], v12 offset:16384
    v_mfma_f32_16x16x32_bf16 v[164:167], v[56:59], v[28:31], v[164:167]
    ds_read_b64_tr_b16 v[26:27], v12 offset:18432
    v_mfma_f32_16x16x32_bf16 v[168:171], v[60:63], v[28:31], v[168:171]
    v_mfma_f32_16x16x32_bf16 v[172:175], v[64:67], v[28:31], v[172:175]
    s_waitcnt lgkmcnt(2)
    v_mfma_f32_16x16x32_bf16 v[188:191], v[64:67], v[20:23], v[188:191]
    ds_read_b64_tr_b16 v[28:29], v13 offset:16384
    v_mfma_f32_16x16x32_bf16 v[184:187], v[60:63], v[20:23], v[184:187]
    ds_read_b64_tr_b16 v[30:31], v13 offset:18432
    v_mfma_f32_16x16x32_bf16 v[180:183], v[56:59], v[20:23], v[180:183]
    v_mfma_f32_16x16x32_bf16 v[176:179], v[52:55], v[20:23], v[176:179]
    s_waitcnt lgkmcnt(2)
    v_mfma_f32_16x16x32_bf16 v[192:195], v[52:55], v[24:27], v[192:195]
    ds_read_b64_tr_b16 v[20:21], v14 offset:16384
    v_mfma_f32_16x16x32_bf16 v[196:199], v[56:59], v[24:27], v[196:199]
    ds_read_b64_tr_b16 v[22:23], v14 offset:18432
    v_mfma_f32_16x16x32_bf16 v[200:203], v[60:63], v[24:27], v[200:203]
    v_mfma_f32_16x16x32_bf16 v[204:207], v[64:67], v[24:27], v[204:207]
    s_waitcnt lgkmcnt(0)
    s_barrier
    v_mfma_f32_16x16x32_bf16 v[220:223], v[64:67], v[28:31], v[220:223]
    ds_read_b64_tr_b16 v[24:25], v8 offset:32768
    ds_read_b128 v[36:39], v16 offset:49152
    v_mfma_f32_16x16x32_bf16 v[216:219], v[60:63], v[28:31], v[216:219]
    ds_read_b64_tr_b16 v[26:27], v8 offset:34816
    ds_read_b128 v[40:43], v16 offset:51200
    v_mfma_f32_16x16x32_bf16 v[212:215], v[56:59], v[28:31], v[212:215]
    ds_read_b128 v[44:47], v18 offset:49152
    v_mfma_f32_16x16x32_bf16 v[208:211], v[52:55], v[28:31], v[208:211]
    ds_read_b128 v[48:51], v18 offset:51200
    v_mfma_f32_16x16x32_bf16 v[224:227], v[52:55], v[20:23], v[224:227]
    ds_read_b64_tr_b16 v[28:29], v9 offset:32768
    v_mfma_f32_16x16x32_bf16 v[228:231], v[56:59], v[20:23], v[228:231]
    ds_read_b64_tr_b16 v[30:31], v9 offset:34816
    v_mfma_f32_16x16x32_bf16 v[232:235], v[60:63], v[20:23], v[232:235]
    v_mfma_f32_16x16x32_bf16 v[236:239], v[64:67], v[20:23], v[236:239]
    s_waitcnt lgkmcnt(5)
    v_mfma_f32_16x16x32_bf16 v[128:131], v[36:39], v[24:27], v[128:131]
    ds_read_b64_tr_b16 v[20:21], v10 offset:32768
    s_waitcnt lgkmcnt(5)
    v_mfma_f32_16x16x32_bf16 v[132:135], v[40:43], v[24:27], v[132:135]
    ds_read_b64_tr_b16 v[22:23], v10 offset:34816
    s_waitcnt lgkmcnt(5)
    v_mfma_f32_16x16x32_bf16 v[136:139], v[44:47], v[24:27], v[136:139]
    s_waitcnt lgkmcnt(4)
    v_mfma_f32_16x16x32_bf16 v[140:143], v[48:51], v[24:27], v[140:143]
    s_waitcnt lgkmcnt(2)
    v_mfma_f32_16x16x32_bf16 v[156:159], v[48:51], v[28:31], v[156:159]
    ds_read_b64_tr_b16 v[24:25], v11 offset:32768
    v_mfma_f32_16x16x32_bf16 v[152:155], v[44:47], v[28:31], v[152:155]
    ds_read_b64_tr_b16 v[26:27], v11 offset:34816
    v_mfma_f32_16x16x32_bf16 v[148:151], v[40:43], v[28:31], v[148:151]
    v_mfma_f32_16x16x32_bf16 v[144:147], v[36:39], v[28:31], v[144:147]
    s_waitcnt lgkmcnt(2)
    v_mfma_f32_16x16x32_bf16 v[160:163], v[36:39], v[20:23], v[160:163]
    ds_read_b64_tr_b16 v[28:29], v12 offset:32768
    v_mfma_f32_16x16x32_bf16 v[164:167], v[40:43], v[20:23], v[164:167]
    ds_read_b64_tr_b16 v[30:31], v12 offset:34816
    v_mfma_f32_16x16x32_bf16 v[168:171], v[44:47], v[20:23], v[168:171]
    v_mfma_f32_16x16x32_bf16 v[172:175], v[48:51], v[20:23], v[172:175]
    s_waitcnt lgkmcnt(2)
    v_mfma_f32_16x16x32_bf16 v[188:191], v[48:51], v[24:27], v[188:191]
    ds_read_b64_tr_b16 v[20:21], v13 offset:32768
    v_mfma_f32_16x16x32_bf16 v[184:187], v[44:47], v[24:27], v[184:187]
    ds_read_b64_tr_b16 v[22:23], v13 offset:34816
    v_mfma_f32_16x16x32_bf16 v[180:183], v[40:43], v[24:27], v[180:183]
    v_mfma_f32_16x16x32_bf16 v[176:179], v[36:39], v[24:27], v[176:179]
    s_waitcnt lgkmcnt(2)
    v_mfma_f32_16x16x32_bf16 v[192:195], v[36:39], v[28:31], v[192:195]
    ds_read_b64_tr_b16 v[24:25], v14 offset:32768
    v_mfma_f32_16x16x32_bf16 v[196:199], v[40:43], v[28:31], v[196:199]
    ds_read_b64_tr_b16 v[26:27], v14 offset:34816
    v_mfma_f32_16x16x32_bf16 v[200:203], v[44:47], v[28:31], v[200:203]
    v_mfma_f32_16x16x32_bf16 v[204:207], v[48:51], v[28:31], v[204:207]
    s_barrier
    s_waitcnt lgkmcnt(2)
    v_mfma_f32_16x16x32_bf16 v[220:223], v[48:51], v[20:23], v[220:223]
    ds_read_b64_tr_b16 v[28:29], v8 offset:49152
    ds_read_b128 v[52:55], v17 offset:49152
    v_mfma_f32_16x16x32_bf16 v[216:219], v[44:47], v[20:23], v[216:219]
    ds_read_b64_tr_b16 v[30:31], v8 offset:51200
    ds_read_b128 v[56:59], v17 offset:51200
    v_mfma_f32_16x16x32_bf16 v[212:215], v[40:43], v[20:23], v[212:215]
    ds_read_b128 v[60:63], v19 offset:49152
    v_mfma_f32_16x16x32_bf16 v[208:211], v[36:39], v[20:23], v[208:211]
    ds_read_b128 v[64:67], v19 offset:51200
    s_waitcnt lgkmcnt(6)
    v_mfma_f32_16x16x32_bf16 v[224:227], v[36:39], v[24:27], v[224:227]
    ds_read_b64_tr_b16 v[20:21], v9 offset:49152
    v_mfma_f32_16x16x32_bf16 v[228:231], v[40:43], v[24:27], v[228:231]
    ds_read_b64_tr_b16 v[22:23], v9 offset:51200
    v_mfma_f32_16x16x32_bf16 v[232:235], v[44:47], v[24:27], v[232:235]
    v_mfma_f32_16x16x32_bf16 v[236:239], v[48:51], v[24:27], v[236:239]
    s_waitcnt lgkmcnt(5)
    v_mfma_f32_16x16x32_bf16 v[128:131], v[52:55], v[28:31], v[128:131]
    ds_read_b64_tr_b16 v[24:25], v10 offset:49152
    s_waitcnt lgkmcnt(5)
    v_mfma_f32_16x16x32_bf16 v[132:135], v[56:59], v[28:31], v[132:135]
    ds_read_b64_tr_b16 v[26:27], v10 offset:51200
    s_waitcnt lgkmcnt(5)
    v_mfma_f32_16x16x32_bf16 v[136:139], v[60:63], v[28:31], v[136:139]
    s_waitcnt lgkmcnt(4)
    v_mfma_f32_16x16x32_bf16 v[140:143], v[64:67], v[28:31], v[140:143]
    s_waitcnt lgkmcnt(2)
    v_mfma_f32_16x16x32_bf16 v[156:159], v[64:67], v[20:23], v[156:159]
    ds_read_b64_tr_b16 v[28:29], v11 offset:49152
    v_mfma_f32_16x16x32_bf16 v[152:155], v[60:63], v[20:23], v[152:155]
    ds_read_b64_tr_b16 v[30:31], v11 offset:51200
    v_mfma_f32_16x16x32_bf16 v[148:151], v[56:59], v[20:23], v[148:151]
    v_mfma_f32_16x16x32_bf16 v[144:147], v[52:55], v[20:23], v[144:147]
    s_waitcnt lgkmcnt(2)
    v_mfma_f32_16x16x32_bf16 v[160:163], v[52:55], v[24:27], v[160:163]
    ds_read_b64_tr_b16 v[20:21], v12 offset:49152
    v_mfma_f32_16x16x32_bf16 v[164:167], v[56:59], v[24:27], v[164:167]
    ds_read_b64_tr_b16 v[22:23], v12 offset:51200
    v_mfma_f32_16x16x32_bf16 v[168:171], v[60:63], v[24:27], v[168:171]
    v_mfma_f32_16x16x32_bf16 v[172:175], v[64:67], v[24:27], v[172:175]
    s_waitcnt lgkmcnt(2)
    v_mfma_f32_16x16x32_bf16 v[188:191], v[64:67], v[28:31], v[188:191]
    ds_read_b64_tr_b16 v[24:25], v13 offset:49152
    v_mfma_f32_16x16x32_bf16 v[184:187], v[60:63], v[28:31], v[184:187]
    ds_read_b64_tr_b16 v[26:27], v13 offset:51200
    v_mfma_f32_16x16x32_bf16 v[180:183], v[56:59], v[28:31], v[180:183]
    v_mfma_f32_16x16x32_bf16 v[176:179], v[52:55], v[28:31], v[176:179]
    s_waitcnt lgkmcnt(2)
    v_mfma_f32_16x16x32_bf16 v[192:195], v[52:55], v[20:23], v[192:195]
    ds_read_b64_tr_b16 v[28:29], v14 offset:49152
    v_mfma_f32_16x16x32_bf16 v[196:199], v[56:59], v[20:23], v[196:199]
    ds_read_b64_tr_b16 v[30:31], v14 offset:51200
    v_mfma_f32_16x16x32_bf16 v[200:203], v[60:63], v[20:23], v[200:203]
    v_mfma_f32_16x16x32_bf16 v[204:207], v[64:67], v[20:23], v[204:207]
    s_barrier
    s_waitcnt lgkmcnt(2)
    v_mfma_f32_16x16x32_bf16 v[220:223], v[64:67], v[24:27], v[220:223]
    ds_read_b64_tr_b16 v[20:21], v8 offset:0
    ds_read_b128 v[36:39], v16 offset:32768
    v_mfma_f32_16x16x32_bf16 v[216:219], v[60:63], v[24:27], v[216:219]
    ds_read_b64_tr_b16 v[22:23], v8 offset:2048
    ds_read_b128 v[40:43], v16 offset:34816
    v_mfma_f32_16x16x32_bf16 v[212:215], v[56:59], v[24:27], v[212:215]
    ds_read_b128 v[44:47], v18 offset:32768
    ds_read_b128 v[240:243], v0 offset:0
    v_mfma_f32_16x16x32_bf16 v[208:211], v[52:55], v[24:27], v[208:211]
    ds_read_b128 v[48:51], v18 offset:34816
    s_waitcnt lgkmcnt(7)
    v_mfma_f32_16x16x32_bf16 v[224:227], v[52:55], v[28:31], v[224:227]
    ds_read_b64_tr_b16 v[24:25], v9 offset:0
    ds_read_b128 v[244:247], v0 offset:1024
    v_mfma_f32_16x16x32_bf16 v[228:231], v[56:59], v[28:31], v[228:231]
    ds_read_b64_tr_b16 v[26:27], v9 offset:2048
    ds_read_b128 v[248:251], v0 offset:2048
    v_mfma_f32_16x16x32_bf16 v[232:235], v[60:63], v[28:31], v[232:235]
    ds_read_b128 v[252:255], v0 offset:3072
    v_mfma_f32_16x16x32_bf16 v[236:239], v[64:67], v[28:31], v[236:239]
    s_waitcnt lgkmcnt(9)
    v_mfma_f32_16x16x32_bf16 v[128:131], v[36:39], v[20:23], v[128:131]
    ds_read_b64_tr_b16 v[28:29], v8 offset:16384
    s_waitcnt lgkmcnt(9)
    v_mfma_f32_16x16x32_bf16 v[132:135], v[40:43], v[20:23], v[132:135]
    ds_read_b128 v[52:55], v17 offset:32768
    s_waitcnt lgkmcnt(8)
    v_mfma_f32_16x16x32_bf16 v[136:139], v[44:47], v[20:23], v[136:139]
    ds_read_b128 v[56:59], v17 offset:34816
    s_waitcnt lgkmcnt(8)
    v_mfma_f32_16x16x32_bf16 v[140:143], v[48:51], v[20:23], v[140:143]
    ds_read_b64_tr_b16 v[30:31], v8 offset:18432
    s_waitcnt lgkmcnt(6)
    v_mfma_f32_16x16x32_bf16 v[144:147], v[36:39], v[24:27], v[144:147]
    ds_read_b128 v[60:63], v19 offset:32768
    ds_read_b128 v[64:67], v19 offset:34816
    v_mfma_f32_16x16x32_bf16 v[148:151], v[40:43], v[24:27], v[148:151]
    ds_read_b64_tr_b16 v[20:21], v9 offset:16384
    ds_read_b64_tr_b16 v[22:23], v9 offset:18432
    v_mfma_f32_16x16x32_bf16 v[152:155], v[44:47], v[24:27], v[152:155]
    v_mfma_f32_16x16x32_bf16 v[156:159], v[48:51], v[24:27], v[156:159]
    s_waitcnt lgkmcnt(4)
    v_mfma_f32_16x16x32_bf16 v[128:131], v[52:55], v[28:31], v[128:131]
    ds_read_b64_tr_b16 v[24:25], v10 offset:0
    v_mfma_f32_16x16x32_bf16 v[132:135], v[56:59], v[28:31], v[132:135]
    ds_read_b64_tr_b16 v[26:27], v10 offset:2048
    s_waitcnt lgkmcnt(5)
    v_mfma_f32_16x16x32_bf16 v[136:139], v[60:63], v[28:31], v[136:139]
    s_waitcnt lgkmcnt(4)
    v_mfma_f32_16x16x32_bf16 v[140:143], v[64:67], v[28:31], v[140:143]
    ds_read_b128 v[16:19], v15 offset:0
    s_waitcnt lgkmcnt(3)
    v_mfma_f32_16x16x32_bf16 v[144:147], v[52:55], v[20:23], v[144:147]
    ds_read_b128 v[32:35], v15 offset:1024
    ds_read_b128 v[124:127], v15 offset:2048
    v_mfma_f32_16x16x32_bf16 v[148:151], v[56:59], v[20:23], v[148:151]
    ds_read_b128 v[4:7], v15 offset:3072
    ds_read_b64_tr_b16 v[28:29], v10 offset:16384
    v_mfma_f32_16x16x32_bf16 v[152:155], v[60:63], v[20:23], v[152:155]
    v_cvt_pk_bf16_f32 v128, v128, v129
    v_cvt_pk_bf16_f32 v129, v130, v131
    v_mfma_f32_16x16x32_bf16 v[156:159], v[64:67], v[20:23], v[156:159]
    v_cvt_pk_bf16_f32 v130, v132, v133
    s_waitcnt lgkmcnt(5)
    v_mfma_f32_16x16x32_bf16 v[160:163], v[36:39], v[24:27], v[160:163]
    v_cvt_pk_bf16_f32 v131, v134, v135
    v_cvt_pk_bf16_f32 v136, v136, v137
    v_mfma_f32_16x16x32_bf16 v[164:167], v[40:43], v[24:27], v[164:167]
    v_cvt_pk_bf16_f32 v137, v138, v139
    v_cvt_pk_bf16_f32 v138, v140, v141
    v_mfma_f32_16x16x32_bf16 v[168:171], v[44:47], v[24:27], v[168:171]
    v_cvt_pk_bf16_f32 v139, v142, v143
    ds_read_b64_tr_b16 v[30:31], v10 offset:18432
    v_mfma_f32_16x16x32_bf16 v[172:175], v[48:51], v[24:27], v[172:175]
    ds_read_b64_tr_b16 v[20:21], v11 offset:0
    ds_read_b64_tr_b16 v[22:23], v11 offset:2048
    v_mfma_f32_16x16x32_bf16 v[132:135], v[68:71], v[240:243], 0
    v_add_u32 v8, s40, v2
    v_add_u32 v9, s41, v2
    v_mfma_f32_16x16x32_bf16 v[140:143], v[68:71], v[244:247], 0
    v_mov_b32 v10, s68
    v_cvt_pk_bf16_f32 v144, v144, v145
    v_mfma_f32_16x16x32_bf16 v[132:135], v[128:131], v[248:251], v[132:135]
    v_cvt_pk_bf16_f32 v145, v146, v147
    v_cvt_pk_bf16_f32 v146, v148, v149
    v_mfma_f32_16x16x32_bf16 v[140:143], v[128:131], v[252:255], v[140:143]
    v_cvt_pk_bf16_f32 v147, v150, v151
    s_waitcnt lgkmcnt(3)
    v_mfma_f32_16x16x32_bf16 v[68:71], v[96:99], v[16:19], 0
    v_cvt_pk_bf16_f32 v152, v152, v153
    v_cvt_pk_bf16_f32 v153, v154, v155
    v_mfma_f32_16x16x32_bf16 v[128:131], v[96:99], v[32:35], 0
    v_cvt_pk_bf16_f32 v154, v156, v157
    v_cvt_pk_bf16_f32 v155, v158, v159
    v_mfma_f32_16x16x32_bf16 v[68:71], v[136:139], v[124:127], v[68:71]
    v_cvt_pk_bf16_f32 v132, v132, v133
    v_cvt_pk_bf16_f32 v133, v134, v135
    v_mfma_f32_16x16x32_bf16 v[128:131], v[136:139], v[4:7], v[128:131]
    v_cvt_pk_bf16_f32 v134, v140, v141
    s_waitcnt lgkmcnt(0)
    v_mfma_f32_16x16x32_bf16 v[160:163], v[52:55], v[28:31], v[160:163]
    v_cvt_pk_bf16_f32 v135, v142, v143
    buffer_store_dwordx4 v[132:135], v2, s[60:63], s54 offen offset:0 sc1
    v_mfma_f32_16x16x32_bf16 v[164:167], v[56:59], v[28:31], v[164:167]
    ds_write_b128 v8, v[132:135] offset:0
    ds_read_b64_tr_b16 v[24:25], v11 offset:16384
    v_mfma_f32_16x16x32_bf16 v[168:171], v[60:63], v[28:31], v[168:171]
    v_cvt_pk_bf16_f32 v68, v68, v69
    v_cvt_pk_bf16_f32 v69, v70, v71
    v_mfma_f32_16x16x32_bf16 v[172:175], v[64:67], v[28:31], v[172:175]
    v_cvt_pk_bf16_f32 v70, v128, v129
    v_cvt_pk_bf16_f32 v71, v130, v131
    v_mfma_f32_16x16x32_bf16 v[176:179], v[36:39], v[20:23], v[176:179]
    buffer_store_dwordx4 v[68:71], v2, s[60:63], s55 offen offset:0 sc1
    ds_write_b128 v9, v[68:71] offset:0
    v_mfma_f32_16x16x32_bf16 v[180:183], v[40:43], v[20:23], v[180:183]
    ds_read_b64_tr_b16 v[26:27], v11 offset:18432
    ds_read_b64_tr_b16 v[28:29], v12 offset:0
    v_mfma_f32_16x16x32_bf16 v[184:187], v[44:47], v[20:23], v[184:187]
    ds_read_b64_tr_b16 v[30:31], v12 offset:2048
    v_cvt_pk_bf16_f32 v160, v160, v161
    v_mfma_f32_16x16x32_bf16 v[188:191], v[48:51], v[20:23], v[188:191]
    v_cvt_pk_bf16_f32 v161, v162, v163
    v_cvt_pk_bf16_f32 v162, v164, v165
    v_mfma_f32_16x16x32_bf16 v[148:151], v[72:75], v[240:243], 0
    v_cvt_pk_bf16_f32 v163, v166, v167
    v_cvt_pk_bf16_f32 v168, v168, v169
    v_mfma_f32_16x16x32_bf16 v[156:159], v[72:75], v[244:247], 0
    v_cvt_pk_bf16_f32 v169, v170, v171
    v_cvt_pk_bf16_f32 v170, v172, v173
    v_mfma_f32_16x16x32_bf16 v[148:151], v[144:147], v[248:251], v[148:151]
    v_cvt_pk_bf16_f32 v171, v174, v175
    v_mfma_f32_16x16x32_bf16 v[156:159], v[144:147], v[252:255], v[156:159]
    v_mfma_f32_16x16x32_bf16 v[72:75], v[100:103], v[16:19], 0
    v_mfma_f32_16x16x32_bf16 v[144:147], v[100:103], v[32:35], 0
    v_mfma_f32_16x16x32_bf16 v[72:75], v[152:155], v[124:127], v[72:75]
    s_nop 2
    v_cvt_pk_bf16_f32 v148, v148, v149
    v_cvt_pk_bf16_f32 v149, v150, v151
    v_mfma_f32_16x16x32_bf16 v[144:147], v[152:155], v[4:7], v[144:147]
    v_cvt_pk_bf16_f32 v150, v156, v157
    s_waitcnt lgkmcnt(0)
    v_mfma_f32_16x16x32_bf16 v[176:179], v[52:55], v[24:27], v[176:179]
    v_cvt_pk_bf16_f32 v151, v158, v159
    buffer_store_dwordx4 v[148:151], v2, s[60:63], s54 offen offset:1024 sc1
    v_mfma_f32_16x16x32_bf16 v[180:183], v[56:59], v[24:27], v[180:183]
    ds_write_b128 v8, v[148:151] offset:1024
    ds_read_b64_tr_b16 v[20:21], v12 offset:16384
    v_mfma_f32_16x16x32_bf16 v[184:187], v[60:63], v[24:27], v[184:187]
    v_cvt_pk_bf16_f32 v72, v72, v73
    v_cvt_pk_bf16_f32 v73, v74, v75
    v_mfma_f32_16x16x32_bf16 v[188:191], v[64:67], v[24:27], v[188:191]
    v_cvt_pk_bf16_f32 v74, v144, v145
    v_cvt_pk_bf16_f32 v75, v146, v147
    v_mfma_f32_16x16x32_bf16 v[192:195], v[36:39], v[28:31], v[192:195]
    buffer_store_dwordx4 v[72:75], v2, s[60:63], s55 offen offset:1024 sc1
    ds_write_b128 v9, v[72:75] offset:1024
    v_mfma_f32_16x16x32_bf16 v[196:199], v[40:43], v[28:31], v[196:199]
    ds_read_b64_tr_b16 v[22:23], v12 offset:18432
    ds_read_b64_tr_b16 v[24:25], v13 offset:0
    v_mfma_f32_16x16x32_bf16 v[200:203], v[44:47], v[28:31], v[200:203]
    ds_read_b64_tr_b16 v[26:27], v13 offset:2048
    v_cvt_pk_bf16_f32 v176, v176, v177
    v_mfma_f32_16x16x32_bf16 v[204:207], v[48:51], v[28:31], v[204:207]
    v_cvt_pk_bf16_f32 v177, v178, v179
    v_cvt_pk_bf16_f32 v178, v180, v181
    v_mfma_f32_16x16x32_bf16 v[164:167], v[76:79], v[240:243], 0
    v_cvt_pk_bf16_f32 v179, v182, v183
    v_cvt_pk_bf16_f32 v184, v184, v185
    v_mfma_f32_16x16x32_bf16 v[172:175], v[76:79], v[244:247], 0
    v_cvt_pk_bf16_f32 v185, v186, v187
    v_cvt_pk_bf16_f32 v186, v188, v189
    v_mfma_f32_16x16x32_bf16 v[164:167], v[160:163], v[248:251], v[164:167]
    v_cvt_pk_bf16_f32 v187, v190, v191
    v_mfma_f32_16x16x32_bf16 v[172:175], v[160:163], v[252:255], v[172:175]
    v_mfma_f32_16x16x32_bf16 v[76:79], v[104:107], v[16:19], 0
    v_mfma_f32_16x16x32_bf16 v[160:163], v[104:107], v[32:35], 0
    v_mfma_f32_16x16x32_bf16 v[76:79], v[168:171], v[124:127], v[76:79]
    s_nop 2
    v_cvt_pk_bf16_f32 v164, v164, v165
    v_cvt_pk_bf16_f32 v165, v166, v167
    v_mfma_f32_16x16x32_bf16 v[160:163], v[168:171], v[4:7], v[160:163]
    v_cvt_pk_bf16_f32 v166, v172, v173
    s_waitcnt lgkmcnt(0)
    v_mfma_f32_16x16x32_bf16 v[192:195], v[52:55], v[20:23], v[192:195]
    v_cvt_pk_bf16_f32 v167, v174, v175
    buffer_store_dwordx4 v[164:167], v2, s[60:63], s54 offen offset:2048 sc1
    v_mfma_f32_16x16x32_bf16 v[196:199], v[56:59], v[20:23], v[196:199]
    ds_write_b128 v8, v[164:167] offset:2048
    ds_read_b64_tr_b16 v[28:29], v13 offset:16384
    v_mfma_f32_16x16x32_bf16 v[200:203], v[60:63], v[20:23], v[200:203]
    v_cvt_pk_bf16_f32 v76, v76, v77
    v_cvt_pk_bf16_f32 v77, v78, v79
    v_mfma_f32_16x16x32_bf16 v[204:207], v[64:67], v[20:23], v[204:207]
    v_cvt_pk_bf16_f32 v78, v160, v161
    v_cvt_pk_bf16_f32 v79, v162, v163
    v_mfma_f32_16x16x32_bf16 v[208:211], v[36:39], v[24:27], v[208:211]
    buffer_store_dwordx4 v[76:79], v2, s[60:63], s55 offen offset:2048 sc1
    ds_write_b128 v9, v[76:79] offset:2048
    v_mfma_f32_16x16x32_bf16 v[212:215], v[40:43], v[24:27], v[212:215]
    ds_read_b64_tr_b16 v[30:31], v13 offset:18432
    ds_read_b64_tr_b16 v[20:21], v14 offset:0
    v_mfma_f32_16x16x32_bf16 v[216:219], v[44:47], v[24:27], v[216:219]
    ds_read_b64_tr_b16 v[22:23], v14 offset:2048
    v_cvt_pk_bf16_f32 v192, v192, v193
    v_mfma_f32_16x16x32_bf16 v[220:223], v[48:51], v[24:27], v[220:223]
    v_cvt_pk_bf16_f32 v193, v194, v195
    v_cvt_pk_bf16_f32 v194, v196, v197
    v_mfma_f32_16x16x32_bf16 v[180:183], v[80:83], v[240:243], 0
    v_cvt_pk_bf16_f32 v195, v198, v199
    v_cvt_pk_bf16_f32 v200, v200, v201
    v_mfma_f32_16x16x32_bf16 v[188:191], v[80:83], v[244:247], 0
    v_cvt_pk_bf16_f32 v201, v202, v203
    v_cvt_pk_bf16_f32 v202, v204, v205
    v_mfma_f32_16x16x32_bf16 v[180:183], v[176:179], v[248:251], v[180:183]
    v_cvt_pk_bf16_f32 v203, v206, v207
    v_mfma_f32_16x16x32_bf16 v[188:191], v[176:179], v[252:255], v[188:191]
    v_mfma_f32_16x16x32_bf16 v[80:83], v[108:111], v[16:19], 0
    v_mfma_f32_16x16x32_bf16 v[176:179], v[108:111], v[32:35], 0
    v_mfma_f32_16x16x32_bf16 v[80:83], v[184:187], v[124:127], v[80:83]
    s_nop 2
    v_cvt_pk_bf16_f32 v180, v180, v181
    v_cvt_pk_bf16_f32 v181, v182, v183
    v_mfma_f32_16x16x32_bf16 v[176:179], v[184:187], v[4:7], v[176:179]
    v_cvt_pk_bf16_f32 v182, v188, v189
    s_waitcnt lgkmcnt(0)
    v_mfma_f32_16x16x32_bf16 v[208:211], v[52:55], v[28:31], v[208:211]
    v_cvt_pk_bf16_f32 v183, v190, v191
    buffer_store_dwordx4 v[180:183], v2, s[60:63], s54 offen offset:3072 sc1
    v_mfma_f32_16x16x32_bf16 v[212:215], v[56:59], v[28:31], v[212:215]
    ds_write_b128 v8, v[180:183] offset:3072
    ds_read_b64_tr_b16 v[24:25], v14 offset:16384
    v_mfma_f32_16x16x32_bf16 v[216:219], v[60:63], v[28:31], v[216:219]
    v_cvt_pk_bf16_f32 v80, v80, v81
    v_cvt_pk_bf16_f32 v81, v82, v83
    v_mfma_f32_16x16x32_bf16 v[220:223], v[64:67], v[28:31], v[220:223]
    v_cvt_pk_bf16_f32 v82, v176, v177
    v_cvt_pk_bf16_f32 v83, v178, v179
    v_mfma_f32_16x16x32_bf16 v[224:227], v[36:39], v[20:23], v[224:227]
    buffer_store_dwordx4 v[80:83], v2, s[60:63], s55 offen offset:3072 sc1
    ds_write_b128 v9, v[80:83] offset:3072
    v_mfma_f32_16x16x32_bf16 v[228:231], v[40:43], v[20:23], v[228:231]
    ds_read_b64_tr_b16 v[26:27], v14 offset:18432
    v_mfma_f32_16x16x32_bf16 v[232:235], v[44:47], v[20:23], v[232:235]
    v_cvt_pk_bf16_f32 v208, v208, v209
    v_cvt_pk_bf16_f32 v209, v210, v211
    v_mfma_f32_16x16x32_bf16 v[236:239], v[48:51], v[20:23], v[236:239]
    v_cvt_pk_bf16_f32 v210, v212, v213
    v_cvt_pk_bf16_f32 v211, v214, v215
    v_mfma_f32_16x16x32_bf16 v[196:199], v[84:87], v[240:243], 0
    v_cvt_pk_bf16_f32 v216, v216, v217
    v_cvt_pk_bf16_f32 v217, v218, v219
    v_mfma_f32_16x16x32_bf16 v[204:207], v[84:87], v[244:247], 0
    v_cvt_pk_bf16_f32 v218, v220, v221
    v_cvt_pk_bf16_f32 v219, v222, v223
    v_mfma_f32_16x16x32_bf16 v[196:199], v[192:195], v[248:251], v[196:199]
    v_mfma_f32_16x16x32_bf16 v[204:207], v[192:195], v[252:255], v[204:207]
    v_mfma_f32_16x16x32_bf16 v[84:87], v[112:115], v[16:19], 0
    v_mfma_f32_16x16x32_bf16 v[192:195], v[112:115], v[32:35], 0
    v_mfma_f32_16x16x32_bf16 v[84:87], v[200:203], v[124:127], v[84:87]
    s_nop 3
    v_cvt_pk_bf16_f32 v196, v196, v197
    v_cvt_pk_bf16_f32 v197, v198, v199
    v_mfma_f32_16x16x32_bf16 v[192:195], v[200:203], v[4:7], v[192:195]
    v_cvt_pk_bf16_f32 v198, v204, v205
    s_waitcnt lgkmcnt(0)
    v_mfma_f32_16x16x32_bf16 v[224:227], v[52:55], v[24:27], v[224:227]
    v_cvt_pk_bf16_f32 v199, v206, v207
    s_add_u32 s54, s54, 4096
    buffer_store_dwordx4 v[196:199], v2, s[60:63], s54 offen offset:0 sc1
    v_mfma_f32_16x16x32_bf16 v[228:231], v[56:59], v[24:27], v[228:231]
    ds_write_b128 v8, v[196:199] offset:4096
    v_mfma_f32_16x16x32_bf16 v[232:235], v[60:63], v[24:27], v[232:235]
    v_cvt_pk_bf16_f32 v84, v84, v85
    v_cvt_pk_bf16_f32 v85, v86, v87
    v_mfma_f32_16x16x32_bf16 v[236:239], v[64:67], v[24:27], v[236:239]
    v_cvt_pk_bf16_f32 v86, v192, v193
    v_cvt_pk_bf16_f32 v87, v194, v195
    v_mfma_f32_16x16x32_bf16 v[212:215], v[88:91], v[240:243], 0
    s_add_u32 s55, s55, 4096
    buffer_store_dwordx4 v[84:87], v2, s[60:63], s55 offen offset:0 sc1
    ds_write_b128 v9, v[84:87] offset:4096
    v_mfma_f32_16x16x32_bf16 v[220:223], v[88:91], v[244:247], 0
    v_mfma_f32_16x16x32_bf16 v[212:215], v[208:211], v[248:251], v[212:215]
    v_cvt_pk_bf16_f32 v224, v224, v225
    v_cvt_pk_bf16_f32 v225, v226, v227
    v_mfma_f32_16x16x32_bf16 v[220:223], v[208:211], v[252:255], v[220:223]
    v_cvt_pk_bf16_f32 v226, v228, v229
    v_cvt_pk_bf16_f32 v227, v230, v231
    v_mfma_f32_16x16x32_bf16 v[88:91], v[116:119], v[16:19], 0
    v_cvt_pk_bf16_f32 v232, v232, v233
    v_cvt_pk_bf16_f32 v233, v234, v235
    v_mfma_f32_16x16x32_bf16 v[208:211], v[116:119], v[32:35], 0
    v_cvt_pk_bf16_f32 v234, v236, v237
    v_cvt_pk_bf16_f32 v235, v238, v239
    v_mfma_f32_16x16x32_bf16 v[88:91], v[216:219], v[124:127], v[88:91]
    v_cvt_pk_bf16_f32 v212, v212, v213
    v_cvt_pk_bf16_f32 v213, v214, v215
    v_mfma_f32_16x16x32_bf16 v[208:211], v[216:219], v[4:7], v[208:211]
    v_cvt_pk_bf16_f32 v214, v220, v221
    v_cvt_pk_bf16_f32 v215, v222, v223
    v_mfma_f32_16x16x32_bf16 v[228:231], v[92:95], v[240:243], 0
    buffer_store_dwordx4 v[212:215], v2, s[60:63], s54 offen offset:1024 sc1
    ds_write_b128 v8, v[212:215] offset:5120
    v_mfma_f32_16x16x32_bf16 v[236:239], v[92:95], v[244:247], 0
    v_mfma_f32_16x16x32_bf16 v[228:231], v[224:227], v[248:251], v[228:231]
    v_cvt_pk_bf16_f32 v88, v88, v89
    v_cvt_pk_bf16_f32 v89, v90, v91
    v_mfma_f32_16x16x32_bf16 v[236:239], v[224:227], v[252:255], v[236:239]
    v_cvt_pk_bf16_f32 v90, v208, v209
    v_cvt_pk_bf16_f32 v91, v210, v211
    v_mfma_f32_16x16x32_bf16 v[92:95], v[120:123], v[16:19], 0
    buffer_store_dwordx4 v[88:91], v2, s[60:63], s55 offen offset:1024 sc1
    ds_write_b128 v9, v[88:91] offset:5120
    v_mfma_f32_16x16x32_bf16 v[224:227], v[120:123], v[32:35], 0
    v_mfma_f32_16x16x32_bf16 v[92:95], v[232:235], v[124:127], v[92:95]
    v_cvt_pk_bf16_f32 v228, v228, v229
    v_cvt_pk_bf16_f32 v229, v230, v231
    v_mfma_f32_16x16x32_bf16 v[224:227], v[232:235], v[4:7], v[224:227]
    v_cvt_pk_bf16_f32 v230, v236, v237
    v_cvt_pk_bf16_f32 v231, v238, v239
    buffer_store_dwordx4 v[228:231], v2, s[60:63], s54 offen offset:2048 sc1
    ds_write_b128 v8, v[228:231] offset:6144
    s_nop 0
    v_cvt_pk_bf16_f32 v92, v92, v93
    v_cvt_pk_bf16_f32 v93, v94, v95
    s_nop 0
    v_cvt_pk_bf16_f32 v94, v224, v225
    v_cvt_pk_bf16_f32 v95, v226, v227
    buffer_store_dwordx4 v[92:95], v2, s[60:63], s55 offen offset:2048 sc1
    ds_write_b128 v9, v[92:95] offset:6144
    v_bfe_u32 v12, v2, 4, 4
    v_mul_u32_u24 v12, 1792, v12
    v_lshrrev_b32 v14, 8, v2
    v_lshl_add_u32 v12, v14, 3, v12
    s_lshl_b32 s3, s42, 10
    s_add_u32 s3, s3, 147456
    v_add_u32 v13, s3, v2
    s_waitcnt lgkmcnt(0)
    s_barrier
    s_waitcnt vmcnt(0)
    buffer_atomic_swap v10, v1, s[60:63], 0 offen sc1
    s_cmp_lg_u32 s30, 3
    s_cbranch_scc1 L_cgo
    v_lshlrev_b32 v13, 3, v2
    s_mov_b32 s98, 0
    s_mov_b64 exec, 0xff
L_cpf:
    v_mov_b32 v80, 0
    buffer_atomic_or v80, v13, s[60:63], s97 offen sc0 sc1
    s_waitcnt vmcnt(0)
    v_cmp_ne_u32 vcc, s68, v80
    s_cbranch_vccz L_cpg
    s_add_u32 s98, s98, 1
    s_cmp_lt_u32 s98, 200000
    s_cbranch_scc1 L_cpf
L_cpg:
    s_mov_b64 exec, -1
L_pg5:
    s_cbranch_execz L_pgback
    s_barrier
    s_branch L_cfin
L_cgo:
    ds_read_b128 v[68:71], v13
    s_waitcnt lgkmcnt(0)
    v_lshlrev_b32 v72, 16, v68
    v_and_b32 v73, 0xffff0000, v68
    v_lshlrev_b32 v74, 16, v69
    v_and_b32 v75, 0xffff0000, v69
    v_lshlrev_b32 v76, 16, v70
    v_and_b32 v77, 0xffff0000, v70
    v_lshlrev_b32 v78, 16, v71
    v_and_b32 v79, 0xffff0000, v71
    s_add_u32 s12, s96, 0
    s_cmp_eq_u32 s53, 0
    s_cselect_b32 s12, 0x80000000, s12
    s_add_u32 s13, s96, 7168
    s_cmp_eq_u32 s53, 1
    s_cselect_b32 s13, 0x80000000, s13
    s_add_u32 s14, s96, 14336
    s_cmp_eq_u32 s53, 2
    s_cselect_b32 s14, 0x80000000, s14
    s_add_u32 s15, s96, 21504
    s_cmp_eq_u32 s53, 3
    s_cselect_b32 s15, 0x80000000, s15
    s_add_u32 s16, s96, 28672
    s_cmp_eq_u32 s53, 4
    s_cselect_b32 s16, 0x80000000, s16
    s_add_u32 s17, s96, 35840
    s_cmp_eq_u32 s53, 5
    s_cselect_b32 s17, 0x80000000, s17
    s_add_u32 s18, s96, 43008
    s_cmp_eq_u32 s53, 6
    s_cselect_b32 s18, 0x80000000, s18
    s_add_u32 s19, s96, 50176
    s_cmp_eq_u32 s53, 7
    s_cselect_b32 s19, 0x80000000, s19
    s_mov_b32 s11, 0
    s_mov_b32 s98, 0
    s_mov_b32 s10, s53
    s_branch L_sum
L_cfin:
    s_branch L_fin
L_gqa:
    s_barrier
    s_add_u32 s3, s101, 3
    s_and_b32 s3, s3, 3
    s_mul_i32 s4, s3, 57344
    s_add_u32 s4, s4, s90
    s_add_u32 m0, s86, 0
    s_nop 0
    buffer_load_dwordx4 v32, s[56:59], s4 offen offset:0 lds
    buffer_load_dwordx4 v33, s[56:59], s4 offen offset:1024 lds
    buffer_load_dwordx4 v34, s[56:59], s4 offen offset:2048 lds
    buffer_load_dwordx4 v35, s[56:59], s4 offen offset:3072 lds
    s_waitcnt vmcnt(14)
    s_barrier
    s_add_u32 s4, s4, s18
    s_add_u32 m0, s86, 16384
    s_nop 0
    buffer_load_dwordx4 v32, s[56:59], s4 offen offset:0 lds
    buffer_load_dwordx4 v33, s[56:59], s4 offen offset:1024 lds
    buffer_load_dwordx4 v34, s[56:59], s4 offen offset:2048 lds
    buffer_load_dwordx4 v35, s[56:59], s4 offen offset:3072 lds
    s_waitcnt vmcnt(8)
    v_mov_b32 v6, s68
    buffer_atomic_swap v6, v1, s[60:63], s21 offen sc1
    s_barrier
    s_xor_b32 s3, s35, 1
    s_mul_i32 s90, s3, 229376
    s_and_b32 s3, s34, 1
    s_mul_i32 s3, s3, 384
    s_add_u32 s90, s90, s3
    s_mul_i32 s3, s16, 28672
    s_add_u32 s90, s90, s3
    s_add_u32 s3, s101, 0
    s_and_b32 s3, s3, 3
    s_mul_i32 s4, s3, 57344
    s_add_u32 s4, s4, s90
    s_add_u32 m0, s86, 32768
    s_nop 0
    buffer_load_dwordx4 v32, s[56:59], s4 offen offset:0 lds
    buffer_load_dwordx4 v33, s[56:59], s4 offen offset:1024 lds
    buffer_load_dwordx4 v34, s[56:59], s4 offen offset:2048 lds
    buffer_load_dwordx4 v35, s[56:59], s4 offen offset:3072 lds
    s_waitcnt vmcnt(9)
    s_barrier
    s_add_u32 s4, s4, s18
    s_add_u32 m0, s86, 49152
    s_nop 0
    buffer_load_dwordx4 v32, s[56:59], s4 offen offset:0 lds
    buffer_load_dwordx4 v33, s[56:59], s4 offen offset:1024 lds
    buffer_load_dwordx4 v34, s[56:59], s4 offen offset:2048 lds
    buffer_load_dwordx4 v35, s[56:59], s4 offen offset:3072 lds
    s_waitcnt vmcnt(9)
    s_barrier
    v_mov_b32 v7, 0
    buffer_atomic_or v7, v1, s[60:63], s23 offen sc0 sc1
    v_lshlrev_b32 v5, 3, v2
    s_lshl_b32 s3, s69, 8
    v_add_u32 v5, s3, v5
    v_cmp_gt_u32 vcc, 32, v2
    v_mov_b32 v4, 0x80000000
    s_nop 0
    v_cndmask_b32 v5, v4, v5, vcc
    v_mov_b32 v4, 0
    buffer_atomic_or v4, v5, s[60:63], s97 offen sc1
    s_waitcnt vmcnt(6)
    s_barrier
    s_add_u32 s3, s101, 1
    s_and_b32 s3, s3, 3
    s_mul_i32 s4, s3, 57344
    s_add_u32 s4, s4, s90
    s_add_u32 m0, s86, 0
    s_nop 0
    buffer_load_dwordx4 v32, s[56:59], s4 offen offset:0 lds
    buffer_load_dwordx4 v33, s[56:59], s4 offen offset:1024 lds
    buffer_load_dwordx4 v34, s[56:59], s4 offen offset:2048 lds
    buffer_load_dwordx4 v35, s[56:59], s4 offen offset:3072 lds
    s_waitcnt vmcnt(5)
    v_readfirstlane_b32 s3, v7
    s_nop 0
    s_cmp_eq_u32 s3, s68
    s_cbranch_scc1 L_pokg
    s_mov_b32 s98, 0
L_psping:
    v_mov_b32 v7, 0
    buffer_atomic_or v7, v1, s[60:63], s23 offen sc0 sc1
    s_add_u32 s98, s98, 1
    s_cmp_gt_u32 s98, 200000
    s_cbranch_scc1 L_pokg
    s_waitcnt vmcnt(0)
    v_readfirstlane_b32 s3, v7
    s_nop 0
    s_cmp_lg_u32 s3, s68
    s_cbranch_scc1 L_psping
L_pokg:
    s_lshl_b32 s3, s69, 12
    s_add_u32 m0, s3, 133120
    s_nop 0
    buffer_load_dwordx4 v2, s[60:63], s22 offen sc1 lds
    buffer_load_dwordx4 v2, s[60:63], s22 offen offset:1024 sc1 lds
    s_barrier
    s_add_u32 s4, s4, s18
    s_add_u32 m0, s86, 16384
    s_nop 0
    buffer_load_dwordx4 v32, s[56:59], s4 offen offset:0 lds
    buffer_load_dwordx4 v33, s[56:59], s4 offen offset:1024 lds
    buffer_load_dwordx4 v34, s[56:59], s4 offen offset:2048 lds
    buffer_load_dwordx4 v35, s[56:59], s4 offen offset:3072 lds
    s_waitcnt vmcnt(6)
    s_barrier
    s_add_u32 s3, s101, 2
    s_and_b32 s3, s3, 3
    s_mul_i32 s4, s3, 57344
    s_add_u32 s4, s4, s90
    s_add_u32 m0, s86, 32768
    s_nop 0
    buffer_load_dwordx4 v32, s[56:59], s4 offen offset:0 lds
    buffer_load_dwordx4 v33, s[56:59], s4 offen offset:1024 lds
    buffer_load_dwordx4 v34, s[56:59], s4 offen offset:2048 lds
    buffer_load_dwordx4 v35, s[56:59], s4 offen offset:3072 lds
    s_waitcnt vmcnt(4)
    s_barrier
    s_add_u32 s4, s4, s18
    s_add_u32 m0, s86, 49152
    s_nop 0
    buffer_load_dwordx4 v32, s[56:59], s4 offen offset:0 lds
    buffer_load_dwordx4 v33, s[56:59], s4 offen offset:1024 lds
    buffer_load_dwordx4 v34, s[56:59], s4 offen offset:2048 lds
    buffer_load_dwordx4 v35, s[56:59], s4 offen offset:3072 lds
    s_waitcnt vmcnt(4)
    s_barrier
    s_add_u32 s3, s101, 3
    s_and_b32 s3, s3, 3
    s_mul_i32 s4, s3, 57344
    s_add_u32 s4, s4, s90
    s_add_u32 m0, s86, 0
    s_nop 0
    buffer_load_dwordx4 v32, s[56:59], s4 offen offset:0 lds
    buffer_load_dwordx4 v33, s[56:59], s4 offen offset:1024 lds
    buffer_load_dwordx4 v34, s[56:59], s4 offen offset:2048 lds
    buffer_load_dwordx4 v35, s[56:59], s4 offen offset:3072 lds
    s_add_u32 s4, s4, s18
    s_add_u32 m0, s86, 16384
    s_nop 0
    buffer_load_dwordx4 v32, s[56:59], s4 offen offset:0 lds
    buffer_load_dwordx4 v33, s[56:59], s4 offen offset:1024 lds
    buffer_load_dwordx4 v34, s[56:59], s4 offen offset:2048 lds
    buffer_load_dwordx4 v35, s[56:59], s4 offen offset:3072 lds
    s_waitcnt vmcnt(8)
    s_waitcnt lgkmcnt(0)
    s_barrier
    s_waitcnt vmcnt(0)
    s_barrier
    s_branch L_join
L_last:
    s_endpgm
.section .rodata,"a"
.p2align 6
.amdhsa_kernel concat_heads__gqa_block_cached__mha_block_cached__near_ridge_kernel
  .amdhsa_next_free_vgpr 256
  .amdhsa_next_free_sgpr 102
  .amdhsa_accum_offset 256
  .amdhsa_group_segment_fixed_size 0
  .amdhsa_kernarg_size 104
  .amdhsa_user_sgpr_count 2
  .amdhsa_user_sgpr_kernarg_segment_ptr 1
  .amdhsa_system_sgpr_workgroup_id_x 1
.end_amdhsa_kernel
```
